```python
import torch

def _softmax(x, axis=-1):
    return torch.softmax(x, dim=axis)
def _gelu(x):
    return torch.nn.functional.gelu(x, approximate="tanh")
def _silu(x):
    return torch.nn.functional.silu(x)
def _sigmoid(x):
    return torch.sigmoid(x)
def _layernorm(x, axis=-1, eps=1e-5):
    m = x.mean(dim=axis, keepdim=True)
    v = x.var(dim=axis, keepdim=True, unbiased=False)
    return (x - m) / torch.sqrt(v + eps)
def _scatter_add(tgt, idx, src, axis=0):
    return tgt.clone().index_add_(axis, idx, src)
def _segment_sum(src, seg, n):
    out = torch.zeros((n,) + src.shape[1:], dtype=src.dtype)
    return out.index_add_(0, seg, src)
def _pad(x, pw):
    flat = tuple(v for pair in reversed(pw) for v in pair)
    return torch.nn.functional.pad(x, flat)

kernel_name = 'standalone__deep_cross_xdeepfm__recsys'

def setup_inputs():

    _w = (lambda a: (lambda t: t.to(torch.bfloat16) if t.is_floating_point() else t)(torch.as_tensor(a)))
    B, F, D, L = 4096, 26, 16, 3
    V = min(1000000, 100000)
    Din = F * D
    return {
        "idx": _w((lambda lo, hi, *s: torch.randint(lo, hi, s))(0, V, B, F).to(torch.int64)),
        "table": _w((lambda *s: torch.randn(*s, dtype=torch.bfloat16) * 0.8)(V, D)),
        "ws_cin": _w((lambda *s: torch.randn(*s, dtype=torch.bfloat16) * 0.2)(L, F, F, F) * (1.0 / F)),
        "w_cin_out": _w((lambda *s: torch.randn(*s, dtype=torch.bfloat16) * 0.2)(L * F) * ((L * F) ** -0.5)),
        "w_dnn1": _w((lambda *s: torch.randn(*s, dtype=torch.bfloat16) * 0.8)(Din, Din) * (Din ** -0.5)),
        "b_dnn1": _w((lambda *s: torch.randn(*s, dtype=torch.bfloat16) * 3.2)(Din) * 0.1),
        "w_dnn2": _w((lambda *s: torch.randn(*s, dtype=torch.bfloat16) * 0.2)(Din) * (Din ** -0.5)),
        "b_out": _w((lambda *s: torch.randn(*s, dtype=torch.bfloat16) * 0.4)(1)),
    }

def reference(idx, table, ws_cin, w_cin_out, w_dnn1, b_dnn1, w_dnn2, b_out):
    x0 = table[idx]
    B = x0.shape[0]
    L = ws_cin.shape[0]
    xk = x0
    pooled = []
    for l in range(L):
        xk = torch.einsum('bid,bjd,hij->bhd', xk, x0, ws_cin[l])
        pooled.append(xk.sum(axis=-1))
    p_plus = torch.stack(pooled, axis=1).reshape(B, -1)
    logit_cin = p_plus @ w_cin_out
    h = x0.reshape(B, -1)
    h = _gelu(h @ w_dnn1 + b_dnn1)
    logit_dnn = h @ w_dnn2
    return logit_cin + logit_dnn + b_out
```

```asm
; @launch grid=(256,1,1) block=(512,1,1) lds=163840
.amdgcn_target "amdgcn-amd-amdhsa--gfx950"
.text
.globl standalone__deep_cross_xdeepfm__recsys_kernel
.p2align 8
.type standalone__deep_cross_xdeepfm__recsys_kernel,@function
standalone__deep_cross_xdeepfm__recsys_kernel:
    s_cmp_ge_u32 s2, 256
    s_cbranch_scc1 L_end
    s_load_dwordx16 s[4:19], s[0:1], 0
    s_load_dwordx2 s[20:21], s[0:1], 64
    s_getpc_b64 s[88:89]
    s_lshr_b32 s90, s2, 3
    s_and_b32 s90, s90, 31
    s_mul_i32 s90, s90, 10
    v_add_u32 v28, s90, v0
    v_lshlrev_b32 v28, 7, v28
    v_min_u32 v28, CODE_END-standalone__deep_cross_xdeepfm__recsys_kernel-256, v28
    v_mov_b32 v29, s89
    v_add_co_u32 v28, vcc, s88, v28
    s_nop 1
    v_addc_co_u32 v29, vcc, 0, v29, vcc
    v_cmp_gt_u32 vcc, 10, v0
    s_nop 0
    s_and_saveexec_b64 s[92:93], vcc
    s_cbranch_execz L_nopf
    global_load_dword v30, v[28:29], off
L_nopf:
    s_mov_b64 exec, -1
    v_lshrrev_b32 v12, 6, v0
    v_and_b32 v1, 63, v0
    v_and_b32 v2, 15, v0
    v_readfirstlane_b32 s22, v12
    v_bfe_u32 v3, v0, 4, 2
    v_lshrrev_b32 v14, 1, v1
    v_lshlrev_b32 v14, 2, v14
    s_lshl_b32 s61, s2, 4
    s_and_b32 s66, s22, 3
    s_lshl_b32 s62, s66, 2
    s_add_u32 s61, s61, s62
    s_mul_i32 s61, s61, 104
    s_bfe_u32 s23, s2, 0x10003
    v_mov_b32 v8, 0
    v_mov_b32 v9, 0
    v_mov_b32 v10, 0
    v_mov_b32 v11, 0
    v_lshlrev_b32 v12, 4, v0
    ds_write_b128 v12, v[8:11] offset:0
    ds_write_b128 v12, v[8:11] offset:8192
    ds_write_b128 v12, v[8:11] offset:16384
    v_and_b32 v13, 127, v0
    v_lshlrev_b32 v13, 4, v13
    v_add_u32 v13, 147968, v13
    ds_write_b128 v13, v[8:11]
    v_lshlrev_b32 v26, 4, v1
    v_mov_b32 v24, 196608
    s_waitcnt lgkmcnt(0)
    s_cmp_lt_u32 s22, 4
    s_cbranch_scc1 L_touch0
    s_mov_b32 s24, s4
    s_mov_b32 s25, s5
    s_mov_b32 s26, 425984
    s_mov_b32 s27, 0x20000
    buffer_load_dword v4, v14, s[24:27], s61 offen offset:0
    buffer_load_dword v5, v14, s[24:27], s61 offen offset:104
    buffer_load_dword v6, v14, s[24:27], s61 offen offset:208
    buffer_load_dword v7, v14, s[24:27], s61 offen offset:312
L_touch0:
    s_lshr_b32 s62, s2, 3
    s_and_b32 s62, s62, 31
    v_lshlrev_b32 v13, 7, v1
    s_mov_b32 s40, s12
    s_mov_b32 s41, s13
    s_mov_b32 s43, 0x20000
    s_mul_i32 s63, s62, 10880
    s_add_u32 s64, s63, 10880
    s_min_u32 s64, s64, 346112
    s_mov_b32 s42, s64
    s_cmp_eq_u32 s22, 4
    s_cbranch_scc1 L_touch
    s_add_u32 s63, s63, 8192
    s_cmp_eq_u32 s22, 5
    s_cbranch_scc1 L_touch
    s_mov_b32 s40, s8
    s_mov_b32 s41, s9
    s_mul_i32 s63, s62, 3328
    s_add_u32 s64, s63, 3328
    s_min_u32 s64, s64, 105456
    s_mov_b32 s42, s64
    s_cmp_eq_u32 s22, 6
    s_cbranch_scc1 L_touch
    s_mov_b32 s40, s6
    s_mov_b32 s41, s7
    s_mov_b32 s42, 3200000
    s_mov_b32 s63, 0
    v_lshlrev_b32 v13, 20, v1
    s_cmp_eq_u32 s22, 7
    s_cbranch_scc1 L_touch
    s_barrier
    s_branch L_C
L_touch:
    buffer_load_dword v31, v13, s[40:43], s63 offen
    s_barrier
    s_branch L_D
L_C:
    s_mov_b32 s68, s10
    s_mov_b32 s69, s11
    s_mov_b32 s70, 156
    s_mov_b32 s71, 0x20000
    v_lshlrev_b32 v14, 1, v1
    buffer_load_ushort v25, v14, s[68:71], 0 offen
    v_lshlrev_b32 v14, 4, v3
    buffer_load_dwordx4 v[32:35], v14, s[68:71], 0 offen offset:104
    s_load_dword s47, s[18:19], 0
    s_and_b32 s62, s66, 1
    v_lshlrev_b32 v16, 1, v3
    v_lshrrev_b32 v17, 1, v2
    v_subrev_u32 v16, s62, v16
    v_subrev_u32 v17, s62, v17
    v_and_b32 v18, 1, v2
    v_mul_u32_u24 v18, 528, v18
    s_lshl_b32 s65, s66, 4
    s_add_u32 s65, s65, 23920
    v_add_u32 v18, s65, v18
    v_add_u32 v23, 0, v16
    v_mad_i32_i24 v20, v23, v23, v23
    v_lshrrev_b32 v20, 1, v20
    v_add3_u32 v20, v20, v17, 0
    v_min_u32 v22, 12, v23
    v_cmp_ge_u32 s[88:89], 13, v23
    v_add_u32 v19, 0, v17
    v_and_b32 v21, 0x7c, v20
    v_cmp_le_u32 s[90:91], v19, v22
    v_lshlrev_b32 v21, 8, v21
    v_lshl_add_u32 v21, v20, 2, v21
    s_and_b64 s[88:89], s[88:89], s[90:91]
    v_add_u32 v21, v21, v18
    v_cndmask_b32 v154, v24, v21, s[88:89]
    v_add_u32 v23, 1, v16
    v_mad_i32_i24 v20, v23, v23, v23
    v_lshrrev_b32 v20, 1, v20
    v_add3_u32 v20, v20, v17, 0
    v_min_u32 v22, 12, v23
    v_cmp_ge_u32 s[92:93], 13, v23
    v_add_u32 v19, 0, v17
    v_and_b32 v21, 0x7c, v20
    v_cmp_le_u32 s[94:95], v19, v22
    v_lshlrev_b32 v21, 8, v21
    v_lshl_add_u32 v21, v20, 2, v21
    s_and_b64 s[92:93], s[92:93], s[94:95]
    v_add_u32 v21, v21, v18
    v_cndmask_b32 v155, v24, v21, s[92:93]
    v_add_u32 v23, 8, v16
    v_mad_i32_i24 v20, v23, v23, v23
    v_lshrrev_b32 v20, 1, v20
    v_add3_u32 v20, v20, v17, 0
    v_min_u32 v22, 12, v23
    v_cmp_ge_u32 s[88:89], 13, v23
    v_add_u32 v19, 0, v17
    v_and_b32 v21, 0x7c, v20
    v_cmp_le_u32 s[90:91], v19, v22
    v_lshlrev_b32 v21, 8, v21
    v_lshl_add_u32 v21, v20, 2, v21
    s_and_b64 s[88:89], s[88:89], s[90:91]
    v_add_u32 v21, v21, v18
    v_cndmask_b32 v156, v24, v21, s[88:89]
    v_add_u32 v23, 9, v16
    v_mad_i32_i24 v20, v23, v23, v23
    v_lshrrev_b32 v20, 1, v20
    v_add3_u32 v20, v20, v17, 0
    v_min_u32 v22, 12, v23
    v_cmp_ge_u32 s[92:93], 13, v23
    v_add_u32 v19, 0, v17
    v_and_b32 v21, 0x7c, v20
    v_cmp_le_u32 s[94:95], v19, v22
    v_lshlrev_b32 v21, 8, v21
    v_lshl_add_u32 v21, v20, 2, v21
    s_and_b64 s[92:93], s[92:93], s[94:95]
    v_add_u32 v21, v21, v18
    v_cndmask_b32 v157, v24, v21, s[92:93]
    v_add_u32 v23, 8, v16
    v_mad_i32_i24 v20, v23, v23, v23
    v_lshrrev_b32 v20, 1, v20
    v_add3_u32 v20, v20, v17, 8
    v_min_u32 v22, 12, v23
    v_cmp_ge_u32 s[88:89], 13, v23
    v_add_u32 v19, 8, v17
    v_and_b32 v21, 0x7c, v20
    v_cmp_le_u32 s[90:91], v19, v22
    v_lshlrev_b32 v21, 8, v21
    v_lshl_add_u32 v21, v20, 2, v21
    s_and_b64 s[88:89], s[88:89], s[90:91]
    v_add_u32 v21, v21, v18
    v_cndmask_b32 v158, v24, v21, s[88:89]
    v_add_u32 v23, 9, v16
    v_mad_i32_i24 v20, v23, v23, v23
    v_lshrrev_b32 v20, 1, v20
    v_add3_u32 v20, v20, v17, 8
    v_min_u32 v22, 12, v23
    v_cmp_ge_u32 s[92:93], 13, v23
    v_add_u32 v19, 8, v17
    v_and_b32 v21, 0x7c, v20
    v_cmp_le_u32 s[94:95], v19, v22
    v_lshlrev_b32 v21, 8, v21
    v_lshl_add_u32 v21, v20, 2, v21
    s_and_b64 s[92:93], s[92:93], s[94:95]
    v_add_u32 v21, v21, v18
    v_cndmask_b32 v159, v24, v21, s[92:93]
    v_lshrrev_b32 v13, 2, v2
    v_lshl_add_u32 v13, v3, 3, v13
    v_add_u32 v14, 4, v13
    v_min_u32 v13, 25, v13
    v_min_u32 v14, 25, v14
    v_and_b32 v15, 3, v2
    v_lshlrev_b32 v15, 3, v15
    s_movk_i32 s64, 1352
    v_mad_u32_u24 v72, v13, s64, v15
    v_mad_u32_u24 v73, v14, s64, v15
    s_lshl_b32 s63, s66, 6
    s_add_u32 s63, s63, 0
    v_add_u32 v12, s63, v1
    v_mul_u32_u24 v13, 2521, v12
    v_lshrrev_b32 v13, 16, v13
    v_mul_u32_u24 v14, 26, v13
    v_sub_u32 v14, v12, v14
    v_cmp_gt_u32 vcc, 676, v12
    v_lshrrev_b32 v76, 4, v14
    v_lshlrev_b32 v76, 10, v76
    v_and_b32 v14, 15, v14
    v_lshl_add_u32 v76, v14, 4, v76
    v_lshrrev_b32 v14, 3, v13
    v_lshl_add_u32 v76, v14, 8, v76
    v_and_b32 v13, 7, v13
    v_lshl_add_u32 v76, v13, 1, v76
    v_add_u32 v76, 147968, v76
    v_cndmask_b32 v76, v24, v76, vcc
    s_lshl_b32 s63, s66, 6
    s_add_u32 s63, s63, 256
    v_add_u32 v12, s63, v1
    v_mul_u32_u24 v13, 2521, v12
    v_lshrrev_b32 v13, 16, v13
    v_mul_u32_u24 v14, 26, v13
    v_sub_u32 v14, v12, v14
    v_cmp_gt_u32 vcc, 676, v12
    v_lshrrev_b32 v77, 4, v14
    v_lshlrev_b32 v77, 10, v77
    v_and_b32 v14, 15, v14
    v_lshl_add_u32 v77, v14, 4, v77
    v_lshrrev_b32 v14, 3, v13
    v_lshl_add_u32 v77, v14, 8, v77
    v_and_b32 v13, 7, v13
    v_lshl_add_u32 v77, v13, 1, v77
    v_add_u32 v77, 147968, v77
    v_cndmask_b32 v77, v24, v77, vcc
    s_lshl_b32 s63, s66, 6
    s_add_u32 s63, s63, 512
    v_add_u32 v12, s63, v1
    v_mul_u32_u24 v13, 2521, v12
    v_lshrrev_b32 v13, 16, v13
    v_mul_u32_u24 v14, 26, v13
    v_sub_u32 v14, v12, v14
    v_cmp_gt_u32 vcc, 676, v12
    v_lshrrev_b32 v78, 4, v14
    v_lshlrev_b32 v78, 10, v78
    v_and_b32 v14, 15, v14
    v_lshl_add_u32 v78, v14, 4, v78
    v_lshrrev_b32 v14, 3, v13
    v_lshl_add_u32 v78, v14, 8, v78
    v_and_b32 v13, 7, v13
    v_lshl_add_u32 v78, v13, 1, v78
    v_add_u32 v78, 147968, v78
    v_cndmask_b32 v78, v24, v78, vcc
    s_lshl_b32 s63, s66, 7
    s_add_u32 s63, s63, 23920
    v_add_u32 v37, s63, v72
    v_add_u32 v38, s63, v73
    s_mul_i32 s63, s66, 52
    s_lshl_b32 s64, s62, 2
    s_sub_u32 s63, s63, s64
    s_add_u32 s63, s63, 112816
    v_add_u32 v39, s63, v72
    v_add_u32 v75, s63, v73
    s_lshl_b32 s64, s62, 1
    s_add_u32 s64, s64, 10
    v_cmp_gt_u32 vcc, s64, v2
    s_lshl_b32 s63, s62, 1
    s_nop 0
    v_cndmask_b32 v74, 0, -1, vcc
    v_subrev_u32 v12, s63, v2
    v_min_u32 v12, 31, v12
    v_lshrrev_b32 v13, 4, v12
    v_lshlrev_b32 v13, 10, v13
    v_and_b32 v12, 15, v12
    v_lshl_add_u32 v13, v12, 4, v13
    v_lshl_add_u32 v13, v3, 8, v13
    v_add_u32 v44, 147968, v13
    v_subrev_u32 v12, s63, v2
    v_add_u32 v12, 16, v12
    v_min_u32 v12, 31, v12
    v_lshrrev_b32 v13, 4, v12
    v_lshlrev_b32 v13, 10, v13
    v_and_b32 v12, 15, v12
    v_lshl_add_u32 v13, v12, 4, v13
    v_lshl_add_u32 v13, v3, 8, v13
    v_add_u32 v45, 147968, v13
    v_lshrrev_b32 v13, 5, v1
    v_mul_u32_u24 v14, 528, v13
    v_and_b32 v15, 31, v1
    v_lshl_add_u32 v226, v15, 4, v14
    s_waitcnt vmcnt(0)
    v_lshlrev_b32 v13, 16, v25
    v_cmp_gt_u32 s[88:89], 26, v1
    v_cmp_gt_u32 s[90:91], 32, v1
    v_lshlrev_b32 v14, 2, v1
    v_add_u32 v14, 163328, v14
    v_cndmask_b32 v13, 0, v13, s[88:89]
    v_cndmask_b32 v14, v24, v14, s[90:91]
    ds_write_b32 v14, v13
    v_subrev_u32 v13, 26, v1
    v_cmp_gt_u32 s[88:89], 26, v13
    v_lshrrev_b32 v14, 3, v13
    v_lshlrev_b32 v14, 8, v14
    v_and_b32 v15, 7, v13
    v_lshl_add_u32 v14, v15, 1, v14
    v_add_u32 v14, 149152, v14
    v_cndmask_b32 v14, v24, v14, s[88:89]
    ds_write_b16 v14, v25
    v_cmp_eq_u32 s[88:89], 0, v2
    v_cmp_eq_u32 s[90:91], 4, v2
    v_cmp_eq_u32 s[92:93], 8, v2
    v_cmp_eq_u32 s[94:95], 12, v2
    v_cndmask_b32 v56, 0, v32, s[88:89]
    v_cndmask_b32 v57, 0, v33, s[88:89]
    v_cndmask_b32 v58, 0, v34, s[88:89]
    v_cndmask_b32 v59, 0, v35, s[88:89]
    v_cndmask_b32 v60, 0, v32, s[90:91]
    v_cndmask_b32 v61, 0, v33, s[90:91]
    v_cndmask_b32 v62, 0, v34, s[90:91]
    v_cndmask_b32 v63, 0, v35, s[90:91]
    v_cndmask_b32 v64, 0, v32, s[92:93]
    v_cndmask_b32 v65, 0, v33, s[92:93]
    v_cndmask_b32 v66, 0, v34, s[92:93]
    v_cndmask_b32 v67, 0, v35, s[92:93]
    v_cndmask_b32 v68, 0, v32, s[94:95]
    v_cndmask_b32 v69, 0, v33, s[94:95]
    v_cndmask_b32 v70, 0, v34, s[94:95]
    v_cndmask_b32 v71, 0, v35, s[94:95]
    s_waitcnt lgkmcnt(0)
    s_barrier
    ds_read_b64_tr_b16 v[80:81], v37 offset:0
    ds_read_b64_tr_b16 v[82:83], v38 offset:0
    ds_read_b64_tr_b16 v[84:85], v37 offset:32
    ds_read_b64_tr_b16 v[86:87], v38 offset:32
    ds_read_b64_tr_b16 v[88:89], v37 offset:64
    ds_read_b64_tr_b16 v[90:91], v38 offset:64
    ds_read_b64_tr_b16 v[92:93], v37 offset:96
    ds_read_b64_tr_b16 v[94:95], v38 offset:96
    ds_read_b64_tr_b16 v[96:97], v37 offset:512
    ds_read_b64_tr_b16 v[98:99], v38 offset:512
    ds_read_b64_tr_b16 v[100:101], v37 offset:544
    ds_read_b64_tr_b16 v[102:103], v38 offset:544
    ds_read_b64_tr_b16 v[104:105], v37 offset:576
    ds_read_b64_tr_b16 v[106:107], v38 offset:576
    ds_read_b64_tr_b16 v[108:109], v37 offset:608
    ds_read_b64_tr_b16 v[110:111], v38 offset:608
    ds_read_b64_tr_b16 v[112:113], v37 offset:1024
    ds_read_b64_tr_b16 v[114:115], v38 offset:1024
    ds_read_b64_tr_b16 v[116:117], v37 offset:1056
    ds_read_b64_tr_b16 v[118:119], v38 offset:1056
    ds_read_b64_tr_b16 v[120:121], v37 offset:1088
    ds_read_b64_tr_b16 v[122:123], v38 offset:1088
    ds_read_b64_tr_b16 v[124:125], v37 offset:1120
    ds_read_b64_tr_b16 v[126:127], v38 offset:1120
    s_waitcnt lgkmcnt(15)
    v_mfma_f32_16x16x32_bf16 v[128:131], v[56:59], v[80:83], 0
    v_mfma_f32_16x16x32_bf16 v[128:131], v[60:63], v[84:87], v[128:131]
    v_mfma_f32_16x16x32_bf16 v[128:131], v[64:67], v[88:91], v[128:131]
    v_mfma_f32_16x16x32_bf16 v[128:131], v[68:71], v[92:95], v[128:131]
    s_waitcnt lgkmcnt(8)
    v_mfma_f32_16x16x32_bf16 v[132:135], v[56:59], v[96:99], 0
    v_mfma_f32_16x16x32_bf16 v[132:135], v[60:63], v[100:103], v[132:135]
    v_mfma_f32_16x16x32_bf16 v[132:135], v[64:67], v[104:107], v[132:135]
    v_mfma_f32_16x16x32_bf16 v[132:135], v[68:71], v[108:111], v[132:135]
    s_waitcnt lgkmcnt(0)
    v_mfma_f32_16x16x32_bf16 v[136:139], v[56:59], v[112:115], 0
    v_mfma_f32_16x16x32_bf16 v[136:139], v[60:63], v[116:119], v[136:139]
    v_mfma_f32_16x16x32_bf16 v[136:139], v[64:67], v[120:123], v[136:139]
    v_mfma_f32_16x16x32_bf16 v[136:139], v[68:71], v[124:127], v[136:139]
    s_nop 7
    v_cvt_pk_bf16_f32 v12, v128, v128
    v_cvt_pk_bf16_f32 v13, v132, v132
    v_cvt_pk_bf16_f32 v14, v136, v136
    ds_write_b16 v76, v12
    ds_write_b16 v77, v13
    ds_write_b16 v78, v14
    s_waitcnt vmcnt(0) lgkmcnt(0)
    s_barrier
    ds_read_b128 v[140:143], v44
    ds_read_b128 v[144:147], v45
    ds_read_b64_tr_b16 v[48:49], v39 offset:0
    ds_read_b64_tr_b16 v[50:51], v75 offset:0
    ds_read_b64_tr_b16 v[52:53], v39 offset:32
    ds_read_b64_tr_b16 v[54:55], v75 offset:32
    ds_read_b64_tr_b16 v[56:57], v39 offset:208
    ds_read_b64_tr_b16 v[58:59], v75 offset:208
    ds_read_b64_tr_b16 v[60:61], v39 offset:240
    ds_read_b64_tr_b16 v[62:63], v75 offset:240
    s_waitcnt lgkmcnt(4)
    v_and_b32 v52, v74, v52
    v_and_b32 v53, v74, v53
    v_and_b32 v54, v74, v54
    v_and_b32 v55, v74, v55
    s_nop 0
    v_mfma_f32_16x16x32_bf16 v[160:163], v[48:51], v[140:143], 0
    ds_read_b64_tr_b16 v[64:65], v39 offset:416
    v_mfma_f32_16x16x32_bf16 v[164:167], v[52:55], v[140:143], 0
    ds_read_b64_tr_b16 v[66:67], v75 offset:416
    v_mfma_f32_16x16x32_bf16 v[168:171], v[52:55], v[144:147], 0
    ds_read_b64_tr_b16 v[68:69], v39 offset:448
    v_mfma_f32_16x16x32_bf16 v[160:163], v[140:143], v[48:51], v[160:163]
    ds_read_b64_tr_b16 v[70:71], v75 offset:448
    s_waitcnt lgkmcnt(4)
    v_and_b32 v60, v74, v60
    v_and_b32 v61, v74, v61
    v_and_b32 v62, v74, v62
    v_and_b32 v63, v74, v63
    v_mfma_f32_16x16x32_bf16 v[164:167], v[144:147], v[48:51], v[164:167]
    v_mfma_f32_16x16x32_bf16 v[168:171], v[144:147], v[52:55], v[168:171]
    v_mfma_f32_16x16x32_bf16 v[172:175], v[56:59], v[140:143], 0
    v_cvt_pk_bf16_f32 v184, v160, v161
    ds_read_b64_tr_b16 v[48:49], v39 offset:624
    v_mfma_f32_16x16x32_bf16 v[176:179], v[60:63], v[140:143], 0
    v_cvt_pk_bf16_f32 v185, v162, v163
    ds_read_b64_tr_b16 v[50:51], v75 offset:624
    v_mfma_f32_16x16x32_bf16 v[180:183], v[60:63], v[144:147], 0
    v_cvt_pk_bf16_f32 v186, v164, v165
    ds_read_b64_tr_b16 v[52:53], v39 offset:656
    v_mfma_f32_16x16x32_bf16 v[172:175], v[140:143], v[56:59], v[172:175]
    v_cvt_pk_bf16_f32 v187, v166, v167
    ds_read_b64_tr_b16 v[54:55], v75 offset:656
    s_waitcnt lgkmcnt(4)
    v_and_b32 v68, v74, v68
    v_and_b32 v69, v74, v69
    v_and_b32 v70, v74, v70
    v_and_b32 v71, v74, v71
    v_mfma_f32_16x16x32_bf16 v[176:179], v[144:147], v[56:59], v[176:179]
    v_cvt_pk_bf16_f32 v188, v168, v169
    v_mfma_f32_16x16x32_bf16 v[180:183], v[144:147], v[60:63], v[180:183]
    v_cvt_pk_bf16_f32 v189, v170, v171
    v_mfma_f32_16x16x32_bf16 v[160:163], v[64:67], v[140:143], 0
    ds_write_b32 v154, v184 offset:0
    v_cvt_pk_bf16_f32 v190, v172, v173
    ds_read_b64_tr_b16 v[56:57], v39 offset:832
    v_mfma_f32_16x16x32_bf16 v[164:167], v[68:71], v[140:143], 0
    ds_write_b32 v155, v185 offset:0
    v_cvt_pk_bf16_f32 v191, v174, v175
    ds_read_b64_tr_b16 v[58:59], v75 offset:832
    v_mfma_f32_16x16x32_bf16 v[168:171], v[68:71], v[144:147], 0
    ds_write_b32 v156, v186 offset:0
    v_cvt_pk_bf16_f32 v192, v176, v177
    ds_read_b64_tr_b16 v[60:61], v39 offset:864
    v_mfma_f32_16x16x32_bf16 v[160:163], v[140:143], v[64:67], v[160:163]
    ds_write_b32 v157, v187 offset:0
    v_cvt_pk_bf16_f32 v193, v178, v179
    ds_read_b64_tr_b16 v[62:63], v75 offset:864
    s_waitcnt lgkmcnt(8)
    v_and_b32 v52, v74, v52
    v_and_b32 v53, v74, v53
    v_and_b32 v54, v74, v54
    v_and_b32 v55, v74, v55
    v_mfma_f32_16x16x32_bf16 v[164:167], v[144:147], v[64:67], v[164:167]
    ds_write_b32 v158, v188 offset:0
    v_cvt_pk_bf16_f32 v194, v180, v181
    v_mfma_f32_16x16x32_bf16 v[168:171], v[144:147], v[68:71], v[168:171]
    ds_write_b32 v159, v189 offset:0
    v_cvt_pk_bf16_f32 v195, v182, v183
    v_mfma_f32_16x16x32_bf16 v[172:175], v[48:51], v[140:143], 0
    ds_write_b32 v154, v190 offset:64
    v_cvt_pk_bf16_f32 v184, v160, v161
    ds_read_b64_tr_b16 v[64:65], v39 offset:1040
    v_mfma_f32_16x16x32_bf16 v[176:179], v[52:55], v[140:143], 0
    ds_write_b32 v155, v191 offset:64
    v_cvt_pk_bf16_f32 v185, v162, v163
    ds_read_b64_tr_b16 v[66:67], v75 offset:1040
    v_mfma_f32_16x16x32_bf16 v[180:183], v[52:55], v[144:147], 0
    ds_write_b32 v156, v192 offset:64
    v_cvt_pk_bf16_f32 v186, v164, v165
    ds_read_b64_tr_b16 v[68:69], v39 offset:1072
    v_mfma_f32_16x16x32_bf16 v[172:175], v[140:143], v[48:51], v[172:175]
    ds_write_b32 v157, v193 offset:64
    v_cvt_pk_bf16_f32 v187, v166, v167
    ds_read_b64_tr_b16 v[70:71], v75 offset:1072
    s_waitcnt lgkmcnt(10)
    v_and_b32 v60, v74, v60
    v_and_b32 v61, v74, v61
    v_and_b32 v62, v74, v62
    v_and_b32 v63, v74, v63
    v_mfma_f32_16x16x32_bf16 v[176:179], v[144:147], v[48:51], v[176:179]
    ds_write_b32 v158, v194 offset:64
    v_cvt_pk_bf16_f32 v188, v168, v169
    v_mfma_f32_16x16x32_bf16 v[180:183], v[144:147], v[52:55], v[180:183]
    ds_write_b32 v159, v195 offset:64
    v_cvt_pk_bf16_f32 v189, v170, v171
    v_mfma_f32_16x16x32_bf16 v[160:163], v[56:59], v[140:143], 0
    ds_write_b32 v154, v184 offset:128
    v_cvt_pk_bf16_f32 v190, v172, v173
    ds_read_b64_tr_b16 v[48:49], v39 offset:1248
    v_mfma_f32_16x16x32_bf16 v[164:167], v[60:63], v[140:143], 0
    ds_write_b32 v155, v185 offset:128
    v_cvt_pk_bf16_f32 v191, v174, v175
    ds_read_b64_tr_b16 v[50:51], v75 offset:1248
    v_mfma_f32_16x16x32_bf16 v[168:171], v[60:63], v[144:147], 0
    ds_write_b32 v156, v186 offset:128
    v_cvt_pk_bf16_f32 v192, v176, v177
    ds_read_b64_tr_b16 v[52:53], v39 offset:1280
    v_mfma_f32_16x16x32_bf16 v[160:163], v[140:143], v[56:59], v[160:163]
    ds_write_b32 v157, v187 offset:128
    v_cvt_pk_bf16_f32 v193, v178, v179
    ds_read_b64_tr_b16 v[54:55], v75 offset:1280
    s_waitcnt lgkmcnt(10)
    v_and_b32 v68, v74, v68
    v_and_b32 v69, v74, v69
    v_and_b32 v70, v74, v70
    v_and_b32 v71, v74, v71
    v_mfma_f32_16x16x32_bf16 v[164:167], v[144:147], v[56:59], v[164:167]
    ds_write_b32 v158, v188 offset:128
    v_cvt_pk_bf16_f32 v194, v180, v181
    v_mfma_f32_16x16x32_bf16 v[168:171], v[144:147], v[60:63], v[168:171]
    ds_write_b32 v159, v189 offset:128
    v_cvt_pk_bf16_f32 v195, v182, v183
    v_mfma_f32_16x16x32_bf16 v[172:175], v[64:67], v[140:143], 0
    ds_write_b32 v154, v190 offset:192
    v_cvt_pk_bf16_f32 v184, v160, v161
    v_mfma_f32_16x16x32_bf16 v[176:179], v[68:71], v[140:143], 0
    ds_write_b32 v155, v191 offset:192
    v_cvt_pk_bf16_f32 v185, v162, v163
    v_mfma_f32_16x16x32_bf16 v[180:183], v[68:71], v[144:147], 0
    ds_write_b32 v156, v192 offset:192
    v_cvt_pk_bf16_f32 v186, v164, v165
    v_mfma_f32_16x16x32_bf16 v[172:175], v[140:143], v[64:67], v[172:175]
    ds_write_b32 v157, v193 offset:192
    v_cvt_pk_bf16_f32 v187, v166, v167
    s_waitcnt lgkmcnt(6)
    v_and_b32 v52, v74, v52
    v_and_b32 v53, v74, v53
    v_and_b32 v54, v74, v54
    v_and_b32 v55, v74, v55
    v_mfma_f32_16x16x32_bf16 v[176:179], v[144:147], v[64:67], v[176:179]
    ds_write_b32 v158, v194 offset:192
    v_cvt_pk_bf16_f32 v188, v168, v169
    v_mfma_f32_16x16x32_bf16 v[180:183], v[144:147], v[68:71], v[180:183]
    ds_write_b32 v159, v195 offset:192
    v_cvt_pk_bf16_f32 v189, v170, v171
    v_mfma_f32_16x16x32_bf16 v[160:163], v[48:51], v[140:143], 0
    ds_write_b32 v154, v184 offset:256
    v_cvt_pk_bf16_f32 v190, v172, v173
    v_mfma_f32_16x16x32_bf16 v[164:167], v[52:55], v[140:143], 0
    ds_write_b32 v155, v185 offset:256
    v_cvt_pk_bf16_f32 v191, v174, v175
    v_mfma_f32_16x16x32_bf16 v[168:171], v[52:55], v[144:147], 0
    ds_write_b32 v156, v186 offset:256
    v_cvt_pk_bf16_f32 v192, v176, v177
    v_mfma_f32_16x16x32_bf16 v[160:163], v[140:143], v[48:51], v[160:163]
    ds_write_b32 v157, v187 offset:256
    v_cvt_pk_bf16_f32 v193, v178, v179
    v_mfma_f32_16x16x32_bf16 v[164:167], v[144:147], v[48:51], v[164:167]
    ds_write_b32 v158, v188 offset:256
    v_cvt_pk_bf16_f32 v194, v180, v181
    v_mfma_f32_16x16x32_bf16 v[168:171], v[144:147], v[52:55], v[168:171]
    ds_write_b32 v159, v189 offset:256
    v_cvt_pk_bf16_f32 v195, v182, v183
    s_nop 3
    ds_write_b32 v154, v190 offset:320
    v_cvt_pk_bf16_f32 v184, v160, v161
    ds_write_b32 v155, v191 offset:320
    v_cvt_pk_bf16_f32 v185, v162, v163
    ds_write_b32 v156, v192 offset:320
    v_cvt_pk_bf16_f32 v186, v164, v165
    ds_write_b32 v157, v193 offset:320
    v_cvt_pk_bf16_f32 v187, v166, v167
    ds_write_b32 v158, v194 offset:320
    v_cvt_pk_bf16_f32 v188, v168, v169
    ds_write_b32 v159, v195 offset:320
    v_cvt_pk_bf16_f32 v189, v170, v171
    s_cmp_lt_u32 s66, 2
    s_cbranch_scc1 L_s2v
    v_mov_b32 v154, v24
    v_mov_b32 v155, v24
    v_mov_b32 v156, v24
    v_mov_b32 v157, v24
    v_mov_b32 v158, v24
    v_mov_b32 v159, v24
L_s2v:
    ds_write_b32 v154, v184 offset:384
    ds_write_b32 v155, v185 offset:384
    ds_write_b32 v156, v186 offset:384
    ds_write_b32 v157, v187 offset:384
    ds_write_b32 v158, v188 offset:384
    ds_write_b32 v159, v189 offset:384
    s_waitcnt lgkmcnt(0)
    s_barrier
    s_barrier
    v_and_b32 v204, 1, v3
    s_lshl_b32 s63, s66, 2
    v_add_u32 v204, s63, v204
    v_mul_u32_u24 v204, 832, v204
    v_lshrrev_b32 v205, 2, v2
    v_lshl_add_u32 v204, v205, 5, v204
    v_and_b32 v205, 3, v2
    v_lshl_add_u32 v204, v205, 3, v204
    v_add_u32 v224, 150016, v204
    ds_read_b64_tr_b16 v[176:177], v224 offset:0
    ds_read_b64_tr_b16 v[178:179], v224 offset:128
    ds_read_b64_tr_b16 v[180:181], v224 offset:256
    ds_read_b64_tr_b16 v[182:183], v224 offset:384
    ds_read_b64_tr_b16 v[184:185], v224 offset:512
    ds_read_b64_tr_b16 v[186:187], v224 offset:640
    ds_read_b64_tr_b16 v[188:189], v224 offset:768
    ds_read_b64_tr_b16 v[190:191], v224 offset:1664
    ds_read_b64_tr_b16 v[192:193], v224 offset:1792
    ds_read_b64_tr_b16 v[194:195], v224 offset:1920
    ds_read_b64_tr_b16 v[196:197], v224 offset:2048
    ds_read_b64_tr_b16 v[198:199], v224 offset:2176
    ds_read_b64_tr_b16 v[200:201], v224 offset:2304
    ds_read_b64_tr_b16 v[202:203], v224 offset:2432
    v_lshrrev_b32 v205, 5, v1
    v_lshlrev_b32 v206, 4, v205
    v_add_u32 v206, 163328, v206
    ds_read_b128 v[208:211], v206 offset:0
    ds_read_b128 v[212:215], v206 offset:32
    ds_read_b128 v[216:219], v206 offset:64
    ds_read_b128 v[220:223], v206 offset:96
    v_cmp_eq_u32 s[72:73], 1, v205
    s_waitcnt lgkmcnt(11)
    v_lshlrev_b32 v8, 16, v176
    v_and_b32 v9, 0xffff0000, v176
    v_lshlrev_b32 v10, 16, v177
    v_and_b32 v11, 0xffff0000, v177
    v_lshlrev_b32 v12, 16, v178
    v_and_b32 v13, 0xffff0000, v178
    v_lshlrev_b32 v14, 16, v179
    v_and_b32 v15, 0xffff0000, v179
    v_lshlrev_b32 v16, 16, v180
    v_and_b32 v17, 0xffff0000, v180
    v_lshlrev_b32 v18, 16, v181
    v_and_b32 v19, 0xffff0000, v181
    v_lshlrev_b32 v20, 16, v182
    v_and_b32 v21, 0xffff0000, v182
    v_lshlrev_b32 v22, 16, v183
    v_and_b32 v23, 0xffff0000, v183
    v_lshlrev_b32 v24, 16, v184
    v_and_b32 v25, 0xffff0000, v184
    v_lshlrev_b32 v26, 16, v185
    v_and_b32 v27, 0xffff0000, v185
    v_lshlrev_b32 v28, 16, v186
    v_and_b32 v29, 0xffff0000, v186
    v_lshlrev_b32 v30, 16, v187
    v_and_b32 v31, 0xffff0000, v187
    v_lshlrev_b32 v32, 16, v188
    v_and_b32 v33, 0xffff0000, v188
    v_cndmask_b32 v34, v8, v9, s[72:73]
    v_cndmask_b32 v35, v10, v11, s[72:73]
    v_cndmask_b32 v36, v12, v13, s[72:73]
    v_cndmask_b32 v37, v14, v15, s[72:73]
    v_cndmask_b32 v38, v16, v17, s[72:73]
    v_cndmask_b32 v39, v18, v19, s[72:73]
    v_cndmask_b32 v40, v20, v21, s[72:73]
    v_cndmask_b32 v41, v22, v23, s[72:73]
    v_cndmask_b32 v42, v24, v25, s[72:73]
    v_cndmask_b32 v43, v26, v27, s[72:73]
    v_cndmask_b32 v44, v28, v29, s[72:73]
    v_cndmask_b32 v45, v30, v31, s[72:73]
    v_cndmask_b32 v46, v32, v33, s[72:73]
    s_waitcnt lgkmcnt(4)
    v_lshlrev_b32 v47, 16, v190
    v_and_b32 v48, 0xffff0000, v190
    v_lshlrev_b32 v49, 16, v191
    v_and_b32 v50, 0xffff0000, v191
    v_lshlrev_b32 v51, 16, v192
    v_and_b32 v52, 0xffff0000, v192
    v_lshlrev_b32 v53, 16, v193
    v_and_b32 v54, 0xffff0000, v193
    v_lshlrev_b32 v55, 16, v194
    v_and_b32 v56, 0xffff0000, v194
    v_lshlrev_b32 v57, 16, v195
    v_and_b32 v58, 0xffff0000, v195
    v_lshlrev_b32 v59, 16, v196
    v_and_b32 v60, 0xffff0000, v196
    v_lshlrev_b32 v61, 16, v197
    v_and_b32 v62, 0xffff0000, v197
    v_lshlrev_b32 v63, 16, v198
    v_and_b32 v64, 0xffff0000, v198
    v_lshlrev_b32 v65, 16, v199
    v_and_b32 v66, 0xffff0000, v199
    v_lshlrev_b32 v67, 16, v200
    v_and_b32 v68, 0xffff0000, v200
    v_lshlrev_b32 v69, 16, v201
    v_and_b32 v70, 0xffff0000, v201
    v_lshlrev_b32 v71, 16, v202
    v_and_b32 v72, 0xffff0000, v202
    v_cndmask_b32 v73, v47, v48, s[72:73]
    v_cndmask_b32 v74, v49, v50, s[72:73]
    v_cndmask_b32 v75, v51, v52, s[72:73]
    v_cndmask_b32 v76, v53, v54, s[72:73]
    v_cndmask_b32 v77, v55, v56, s[72:73]
    v_cndmask_b32 v78, v57, v58, s[72:73]
    v_cndmask_b32 v79, v59, v60, s[72:73]
    v_cndmask_b32 v80, v61, v62, s[72:73]
    v_cndmask_b32 v81, v63, v64, s[72:73]
    v_cndmask_b32 v82, v65, v66, s[72:73]
    v_cndmask_b32 v83, v67, v68, s[72:73]
    v_cndmask_b32 v84, v69, v70, s[72:73]
    v_cndmask_b32 v85, v71, v72, s[72:73]
    ds_read_b128 v[176:179], v226 offset:0
    ds_read_b128 v[180:183], v226 offset:23920
    ds_read_b128 v[184:187], v226 offset:1040
    ds_read_b128 v[188:191], v226 offset:24960
    v_mul_f32 v228, 0.5, v34
    v_mul_f32 v200, v8, v228
    v_mul_f32 v201, v9, v228
    v_mul_f32 v202, v10, v34
    v_mul_f32 v203, v11, v34
    v_mul_f32 v228, 0.5, v35
    v_mul_f32 v204, v10, v228
    v_mul_f32 v205, v11, v228
    v_mul_f32 v206, v12, v34
    v_mul_f32 v207, v13, v34
    v_cvt_pk_bf16_f32 v160, v200, v201
    v_cvt_pk_bf16_f32 v161, v202, v203
    v_cvt_pk_bf16_f32 v162, v204, v205
    v_cvt_pk_bf16_f32 v163, v206, v207
    v_mul_f32 v229, 0.5, v73
    v_mul_f32 v200, v47, v229
    v_mul_f32 v201, v48, v229
    v_mul_f32 v202, v49, v73
    v_mul_f32 v203, v50, v73
    v_mul_f32 v229, 0.5, v74
    v_mul_f32 v204, v49, v229
    v_mul_f32 v205, v50, v229
    v_mul_f32 v206, v51, v73
    v_mul_f32 v207, v52, v73
    v_cvt_pk_bf16_f32 v164, v200, v201
    v_cvt_pk_bf16_f32 v165, v202, v203
    v_cvt_pk_bf16_f32 v166, v204, v205
    v_cvt_pk_bf16_f32 v167, v206, v207
    s_waitcnt lgkmcnt(2)
    s_nop 1
    v_mfma_f32_32x32x16_bf16 v[96:111], v[176:179], v[160:163], 0
    ds_read_b128 v[192:195], v226 offset:2080
    v_mul_f32 v200, v12, v35
    v_mul_f32 v201, v13, v35
    v_mul_f32 v228, 0.5, v36
    v_mul_f32 v202, v12, v228
    v_mul_f32 v203, v13, v228
    v_mul_f32 v204, v14, v34
    v_mul_f32 v205, v15, v34
    v_mfma_f32_32x32x16_bf16 v[112:127], v[180:183], v[160:163], v[208:223]
    ds_read_b128 v[196:199], v226 offset:26000
    v_mul_f32 v206, v14, v35
    v_mul_f32 v207, v15, v35
    v_cvt_pk_bf16_f32 v168, v200, v201
    v_cvt_pk_bf16_f32 v169, v202, v203
    v_cvt_pk_bf16_f32 v170, v204, v205
    v_cvt_pk_bf16_f32 v171, v206, v207
    v_mul_f32 v200, v51, v74
    v_mfma_f32_32x32x16_bf16 v[128:143], v[176:179], v[164:167], 0
    v_mul_f32 v201, v52, v74
    v_mul_f32 v229, 0.5, v75
    v_mul_f32 v202, v51, v229
    v_mul_f32 v203, v52, v229
    v_mul_f32 v204, v53, v73
    v_mul_f32 v205, v54, v73
    v_mul_f32 v206, v53, v74
    v_mfma_f32_32x32x16_bf16 v[144:159], v[180:183], v[164:167], v[208:223]
    v_mul_f32 v207, v54, v74
    v_cvt_pk_bf16_f32 v172, v200, v201
    v_cvt_pk_bf16_f32 v173, v202, v203
    v_cvt_pk_bf16_f32 v174, v204, v205
    v_cvt_pk_bf16_f32 v175, v206, v207
    s_waitcnt lgkmcnt(2)
    v_mfma_f32_32x32x16_bf16 v[96:111], v[184:187], v[168:171], v[96:111]
    ds_read_b128 v[176:179], v226 offset:3120
    v_mul_f32 v200, v14, v36
    v_mul_f32 v201, v15, v36
    v_mul_f32 v228, 0.5, v37
    v_mul_f32 v202, v14, v228
    v_mul_f32 v203, v15, v228
    v_mul_f32 v204, v16, v34
    v_mul_f32 v205, v17, v34
    v_mfma_f32_32x32x16_bf16 v[112:127], v[188:191], v[168:171], v[112:127]
    ds_read_b128 v[180:183], v226 offset:27040
    v_mul_f32 v206, v16, v35
    v_mul_f32 v207, v17, v35
    v_cvt_pk_bf16_f32 v160, v200, v201
    v_cvt_pk_bf16_f32 v161, v202, v203
    v_cvt_pk_bf16_f32 v162, v204, v205
    v_cvt_pk_bf16_f32 v163, v206, v207
    v_mul_f32 v200, v53, v75
    v_mfma_f32_32x32x16_bf16 v[128:143], v[184:187], v[172:175], v[128:143]
    v_mul_f32 v201, v54, v75
    v_mul_f32 v229, 0.5, v76
    v_mul_f32 v202, v53, v229
    v_mul_f32 v203, v54, v229
    v_mul_f32 v204, v55, v73
    v_mul_f32 v205, v56, v73
    v_mul_f32 v206, v55, v74
    v_mfma_f32_32x32x16_bf16 v[144:159], v[188:191], v[172:175], v[144:159]
    v_mul_f32 v207, v56, v74
    v_cvt_pk_bf16_f32 v164, v200, v201
    v_cvt_pk_bf16_f32 v165, v202, v203
    v_cvt_pk_bf16_f32 v166, v204, v205
    v_cvt_pk_bf16_f32 v167, v206, v207
    s_waitcnt lgkmcnt(2)
    v_mfma_f32_32x32x16_bf16 v[96:111], v[192:195], v[160:163], v[96:111]
    ds_read_b128 v[184:187], v226 offset:4160
    v_mul_f32 v200, v16, v36
    v_mul_f32 v201, v17, v36
    v_mul_f32 v202, v16, v37
    v_mul_f32 v203, v17, v37
    v_mul_f32 v228, 0.5, v38
    v_mul_f32 v204, v16, v228
    v_mul_f32 v205, v17, v228
    v_mfma_f32_32x32x16_bf16 v[112:127], v[196:199], v[160:163], v[112:127]
    ds_read_b128 v[188:191], v226 offset:28080
    v_mul_f32 v206, v18, v34
    v_mul_f32 v207, v19, v34
    v_cvt_pk_bf16_f32 v168, v200, v201
    v_cvt_pk_bf16_f32 v169, v202, v203
    v_cvt_pk_bf16_f32 v170, v204, v205
    v_cvt_pk_bf16_f32 v171, v206, v207
    v_mul_f32 v200, v55, v75
    v_mfma_f32_32x32x16_bf16 v[128:143], v[192:195], v[164:167], v[128:143]
    v_mul_f32 v201, v56, v75
    v_mul_f32 v202, v55, v76
    v_mul_f32 v203, v56, v76
    v_mul_f32 v229, 0.5, v77
    v_mul_f32 v204, v55, v229
    v_mul_f32 v205, v56, v229
    v_mul_f32 v206, v57, v73
    v_mfma_f32_32x32x16_bf16 v[144:159], v[196:199], v[164:167], v[144:159]
    v_mul_f32 v207, v58, v73
    v_cvt_pk_bf16_f32 v172, v200, v201
    v_cvt_pk_bf16_f32 v173, v202, v203
    v_cvt_pk_bf16_f32 v174, v204, v205
    v_cvt_pk_bf16_f32 v175, v206, v207
    s_waitcnt lgkmcnt(2)
    v_mfma_f32_32x32x16_bf16 v[96:111], v[176:179], v[168:171], v[96:111]
    ds_read_b128 v[192:195], v226 offset:5200
    v_mul_f32 v200, v18, v35
    v_mul_f32 v201, v19, v35
    v_mul_f32 v202, v18, v36
    v_mul_f32 v203, v19, v36
    v_mul_f32 v204, v18, v37
    v_mul_f32 v205, v19, v37
    v_mfma_f32_32x32x16_bf16 v[112:127], v[180:183], v[168:171], v[112:127]
    ds_read_b128 v[196:199], v226 offset:29120
    v_mul_f32 v206, v18, v38
    v_mul_f32 v207, v19, v38
    v_cvt_pk_bf16_f32 v160, v200, v201
    v_cvt_pk_bf16_f32 v161, v202, v203
    v_cvt_pk_bf16_f32 v162, v204, v205
    v_cvt_pk_bf16_f32 v163, v206, v207
    v_mfma_f32_32x32x16_bf16 v[128:143], v[176:179], v[172:175], v[128:143]
    v_mul_f32 v200, v57, v74
    v_mul_f32 v201, v58, v74
    v_mul_f32 v202, v57, v75
    v_mul_f32 v203, v58, v75
    v_mul_f32 v204, v57, v76
    v_mul_f32 v205, v58, v76
    v_mfma_f32_32x32x16_bf16 v[144:159], v[180:183], v[172:175], v[144:159]
    v_mul_f32 v206, v57, v77
    v_mul_f32 v207, v58, v77
    v_cvt_pk_bf16_f32 v164, v200, v201
    v_cvt_pk_bf16_f32 v165, v202, v203
    v_cvt_pk_bf16_f32 v166, v204, v205
    v_cvt_pk_bf16_f32 v167, v206, v207
    s_waitcnt lgkmcnt(2)
    v_mfma_f32_32x32x16_bf16 v[96:111], v[184:187], v[160:163], v[96:111]
    ds_read_b128 v[176:179], v226 offset:6240
    v_mul_f32 v228, 0.5, v39
    v_mul_f32 v200, v18, v228
    v_mul_f32 v201, v19, v228
    v_mul_f32 v202, v20, v34
    v_mul_f32 v203, v21, v34
    v_mul_f32 v204, v20, v35
    v_mul_f32 v205, v21, v35
    v_mfma_f32_32x32x16_bf16 v[112:127], v[188:191], v[160:163], v[112:127]
    ds_read_b128 v[180:183], v226 offset:30160
    v_mul_f32 v206, v20, v36
    v_mul_f32 v207, v21, v36
    v_cvt_pk_bf16_f32 v168, v200, v201
    v_cvt_pk_bf16_f32 v169, v202, v203
    v_cvt_pk_bf16_f32 v170, v204, v205
    v_cvt_pk_bf16_f32 v171, v206, v207
    v_mul_f32 v229, 0.5, v78
    v_mfma_f32_32x32x16_bf16 v[128:143], v[184:187], v[164:167], v[128:143]
    v_mul_f32 v200, v57, v229
    v_mul_f32 v201, v58, v229
    v_mul_f32 v202, v59, v73
    v_mul_f32 v203, v60, v73
    v_mul_f32 v204, v59, v74
    v_mul_f32 v205, v60, v74
    v_mul_f32 v206, v59, v75
    v_mfma_f32_32x32x16_bf16 v[144:159], v[188:191], v[164:167], v[144:159]
    v_mul_f32 v207, v60, v75
    v_cvt_pk_bf16_f32 v172, v200, v201
    v_cvt_pk_bf16_f32 v173, v202, v203
    v_cvt_pk_bf16_f32 v174, v204, v205
    v_cvt_pk_bf16_f32 v175, v206, v207
    s_waitcnt lgkmcnt(2)
    v_mfma_f32_32x32x16_bf16 v[96:111], v[192:195], v[168:171], v[96:111]
    ds_read_b128 v[184:187], v226 offset:7280
    v_mul_f32 v200, v20, v37
    v_mul_f32 v201, v21, v37
    v_mul_f32 v202, v20, v38
    v_mul_f32 v203, v21, v38
    v_mul_f32 v204, v20, v39
    v_mul_f32 v205, v21, v39
    v_mul_f32 v228, 0.5, v40
    v_mfma_f32_32x32x16_bf16 v[112:127], v[196:199], v[168:171], v[112:127]
    ds_read_b128 v[188:191], v226 offset:31200
    v_mul_f32 v206, v20, v228
    v_mul_f32 v207, v21, v228
    v_cvt_pk_bf16_f32 v160, v200, v201
    v_cvt_pk_bf16_f32 v161, v202, v203
    v_cvt_pk_bf16_f32 v162, v204, v205
    v_cvt_pk_bf16_f32 v163, v206, v207
    v_mul_f32 v200, v59, v76
    v_mfma_f32_32x32x16_bf16 v[128:143], v[192:195], v[172:175], v[128:143]
    v_mul_f32 v201, v60, v76
    v_mul_f32 v202, v59, v77
    v_mul_f32 v203, v60, v77
    v_mul_f32 v204, v59, v78
    v_mul_f32 v205, v60, v78
    v_mul_f32 v229, 0.5, v79
    v_mul_f32 v206, v59, v229
    v_mfma_f32_32x32x16_bf16 v[144:159], v[196:199], v[172:175], v[144:159]
    v_mul_f32 v207, v60, v229
    v_cvt_pk_bf16_f32 v164, v200, v201
    v_cvt_pk_bf16_f32 v165, v202, v203
    v_cvt_pk_bf16_f32 v166, v204, v205
    v_cvt_pk_bf16_f32 v167, v206, v207
    s_waitcnt lgkmcnt(2)
    v_mfma_f32_32x32x16_bf16 v[96:111], v[176:179], v[160:163], v[96:111]
    ds_read_b128 v[192:195], v226 offset:8320
    v_mul_f32 v200, v22, v34
    v_mul_f32 v201, v23, v34
    v_mul_f32 v202, v22, v35
    v_mul_f32 v203, v23, v35
    v_mul_f32 v204, v22, v36
    v_mul_f32 v205, v23, v36
    v_mfma_f32_32x32x16_bf16 v[112:127], v[180:183], v[160:163], v[112:127]
    ds_read_b128 v[196:199], v226 offset:32240
    v_mul_f32 v206, v22, v37
    v_mul_f32 v207, v23, v37
    v_cvt_pk_bf16_f32 v168, v200, v201
    v_cvt_pk_bf16_f32 v169, v202, v203
    v_cvt_pk_bf16_f32 v170, v204, v205
    v_cvt_pk_bf16_f32 v171, v206, v207
    v_mfma_f32_32x32x16_bf16 v[128:143], v[176:179], v[164:167], v[128:143]
    v_mul_f32 v200, v61, v73
    v_mul_f32 v201, v62, v73
    v_mul_f32 v202, v61, v74
    v_mul_f32 v203, v62, v74
    v_mul_f32 v204, v61, v75
    v_mul_f32 v205, v62, v75
    v_mfma_f32_32x32x16_bf16 v[144:159], v[180:183], v[164:167], v[144:159]
    v_mul_f32 v206, v61, v76
    v_mul_f32 v207, v62, v76
    v_cvt_pk_bf16_f32 v172, v200, v201
    v_cvt_pk_bf16_f32 v173, v202, v203
    v_cvt_pk_bf16_f32 v174, v204, v205
    v_cvt_pk_bf16_f32 v175, v206, v207
    s_waitcnt lgkmcnt(2)
    v_mfma_f32_32x32x16_bf16 v[96:111], v[184:187], v[168:171], v[96:111]
    ds_read_b128 v[176:179], v226 offset:9360
    v_mul_f32 v200, v22, v38
    v_mul_f32 v201, v23, v38
    v_mul_f32 v202, v22, v39
    v_mul_f32 v203, v23, v39
    v_mul_f32 v204, v22, v40
    v_mul_f32 v205, v23, v40
    v_mul_f32 v228, 0.5, v41
    v_mfma_f32_32x32x16_bf16 v[112:127], v[188:191], v[168:171], v[112:127]
    ds_read_b128 v[180:183], v226 offset:33280
    v_mul_f32 v206, v22, v228
    v_mul_f32 v207, v23, v228
    v_cvt_pk_bf16_f32 v160, v200, v201
    v_cvt_pk_bf16_f32 v161, v202, v203
    v_cvt_pk_bf16_f32 v162, v204, v205
    v_cvt_pk_bf16_f32 v163, v206, v207
    v_mul_f32 v200, v61, v77
    v_mfma_f32_32x32x16_bf16 v[128:143], v[184:187], v[172:175], v[128:143]
    v_mul_f32 v201, v62, v77
    v_mul_f32 v202, v61, v78
    v_mul_f32 v203, v62, v78
    v_mul_f32 v204, v61, v79
    v_mul_f32 v205, v62, v79
    v_mul_f32 v229, 0.5, v80
    v_mul_f32 v206, v61, v229
    v_mfma_f32_32x32x16_bf16 v[144:159], v[188:191], v[172:175], v[144:159]
    v_mul_f32 v207, v62, v229
    v_cvt_pk_bf16_f32 v164, v200, v201
    v_cvt_pk_bf16_f32 v165, v202, v203
    v_cvt_pk_bf16_f32 v166, v204, v205
    v_cvt_pk_bf16_f32 v167, v206, v207
    s_waitcnt lgkmcnt(2)
    v_mfma_f32_32x32x16_bf16 v[96:111], v[192:195], v[160:163], v[96:111]
    ds_read_b128 v[184:187], v226 offset:10400
    v_mul_f32 v200, v24, v34
    v_mul_f32 v201, v25, v34
    v_mul_f32 v202, v24, v35
    v_mul_f32 v203, v25, v35
    v_mul_f32 v204, v24, v36
    v_mul_f32 v205, v25, v36
    v_mfma_f32_32x32x16_bf16 v[112:127], v[196:199], v[160:163], v[112:127]
    ds_read_b128 v[188:191], v226 offset:34320
    v_mul_f32 v206, v24, v37
    v_mul_f32 v207, v25, v37
    v_cvt_pk_bf16_f32 v168, v200, v201
    v_cvt_pk_bf16_f32 v169, v202, v203
    v_cvt_pk_bf16_f32 v170, v204, v205
    v_cvt_pk_bf16_f32 v171, v206, v207
    v_mfma_f32_32x32x16_bf16 v[128:143], v[192:195], v[164:167], v[128:143]
    v_mul_f32 v200, v63, v73
    v_mul_f32 v201, v64, v73
    v_mul_f32 v202, v63, v74
    v_mul_f32 v203, v64, v74
    v_mul_f32 v204, v63, v75
    v_mul_f32 v205, v64, v75
    v_mfma_f32_32x32x16_bf16 v[144:159], v[196:199], v[164:167], v[144:159]
    v_mul_f32 v206, v63, v76
    v_mul_f32 v207, v64, v76
    v_cvt_pk_bf16_f32 v172, v200, v201
    v_cvt_pk_bf16_f32 v173, v202, v203
    v_cvt_pk_bf16_f32 v174, v204, v205
    v_cvt_pk_bf16_f32 v175, v206, v207
    s_waitcnt lgkmcnt(2)
    v_mfma_f32_32x32x16_bf16 v[96:111], v[176:179], v[168:171], v[96:111]
    ds_read_b128 v[192:195], v226 offset:11440
    v_mul_f32 v200, v24, v38
    v_mul_f32 v201, v25, v38
    v_mul_f32 v202, v24, v39
    v_mul_f32 v203, v25, v39
    v_mul_f32 v204, v24, v40
    v_mul_f32 v205, v25, v40
    v_mfma_f32_32x32x16_bf16 v[112:127], v[180:183], v[168:171], v[112:127]
    ds_read_b128 v[196:199], v226 offset:35360
    v_mul_f32 v206, v24, v41
    v_mul_f32 v207, v25, v41
    v_cvt_pk_bf16_f32 v160, v200, v201
    v_cvt_pk_bf16_f32 v161, v202, v203
    v_cvt_pk_bf16_f32 v162, v204, v205
    v_cvt_pk_bf16_f32 v163, v206, v207
    v_mfma_f32_32x32x16_bf16 v[128:143], v[176:179], v[172:175], v[128:143]
    v_mul_f32 v200, v63, v77
    v_mul_f32 v201, v64, v77
    v_mul_f32 v202, v63, v78
    v_mul_f32 v203, v64, v78
    v_mul_f32 v204, v63, v79
    v_mul_f32 v205, v64, v79
    v_mfma_f32_32x32x16_bf16 v[144:159], v[180:183], v[172:175], v[144:159]
    v_mul_f32 v206, v63, v80
    v_mul_f32 v207, v64, v80
    v_cvt_pk_bf16_f32 v164, v200, v201
    v_cvt_pk_bf16_f32 v165, v202, v203
    v_cvt_pk_bf16_f32 v166, v204, v205
    v_cvt_pk_bf16_f32 v167, v206, v207
    s_waitcnt lgkmcnt(2)
    v_mfma_f32_32x32x16_bf16 v[96:111], v[184:187], v[160:163], v[96:111]
    ds_read_b128 v[176:179], v226 offset:12480
    v_mul_f32 v228, 0.5, v42
    v_mul_f32 v200, v24, v228
    v_mul_f32 v201, v25, v228
    v_mul_f32 v202, v26, v34
    v_mul_f32 v203, v27, v34
    v_mul_f32 v204, v26, v35
    v_mul_f32 v205, v27, v35
    v_mfma_f32_32x32x16_bf16 v[112:127], v[188:191], v[160:163], v[112:127]
    ds_read_b128 v[180:183], v226 offset:36400
    v_mul_f32 v206, v26, v36
    v_mul_f32 v207, v27, v36
    v_cvt_pk_bf16_f32 v168, v200, v201
    v_cvt_pk_bf16_f32 v169, v202, v203
    v_cvt_pk_bf16_f32 v170, v204, v205
    v_cvt_pk_bf16_f32 v171, v206, v207
    v_mul_f32 v229, 0.5, v81
    v_mfma_f32_32x32x16_bf16 v[128:143], v[184:187], v[164:167], v[128:143]
    v_mul_f32 v200, v63, v229
    v_mul_f32 v201, v64, v229
    v_mul_f32 v202, v65, v73
    v_mul_f32 v203, v66, v73
    v_mul_f32 v204, v65, v74
    v_mul_f32 v205, v66, v74
    v_mul_f32 v206, v65, v75
    v_mfma_f32_32x32x16_bf16 v[144:159], v[188:191], v[164:167], v[144:159]
    v_mul_f32 v207, v66, v75
    v_cvt_pk_bf16_f32 v172, v200, v201
    v_cvt_pk_bf16_f32 v173, v202, v203
    v_cvt_pk_bf16_f32 v174, v204, v205
    v_cvt_pk_bf16_f32 v175, v206, v207
    s_waitcnt lgkmcnt(2)
    v_mfma_f32_32x32x16_bf16 v[96:111], v[192:195], v[168:171], v[96:111]
    ds_read_b128 v[184:187], v226 offset:13520
    v_mul_f32 v200, v26, v37
    v_mul_f32 v201, v27, v37
    v_mul_f32 v202, v26, v38
    v_mul_f32 v203, v27, v38
    v_mul_f32 v204, v26, v39
    v_mul_f32 v205, v27, v39
    v_mfma_f32_32x32x16_bf16 v[112:127], v[196:199], v[168:171], v[112:127]
    ds_read_b128 v[188:191], v226 offset:37440
    v_mul_f32 v206, v26, v40
    v_mul_f32 v207, v27, v40
    v_cvt_pk_bf16_f32 v160, v200, v201
    v_cvt_pk_bf16_f32 v161, v202, v203
    v_cvt_pk_bf16_f32 v162, v204, v205
    v_cvt_pk_bf16_f32 v163, v206, v207
    v_mfma_f32_32x32x16_bf16 v[128:143], v[192:195], v[172:175], v[128:143]
    v_mul_f32 v200, v65, v76
    v_mul_f32 v201, v66, v76
    v_mul_f32 v202, v65, v77
    v_mul_f32 v203, v66, v77
    v_mul_f32 v204, v65, v78
    v_mul_f32 v205, v66, v78
    v_mfma_f32_32x32x16_bf16 v[144:159], v[196:199], v[172:175], v[144:159]
    v_mul_f32 v206, v65, v79
    v_mul_f32 v207, v66, v79
    v_cvt_pk_bf16_f32 v164, v200, v201
    v_cvt_pk_bf16_f32 v165, v202, v203
    v_cvt_pk_bf16_f32 v166, v204, v205
    v_cvt_pk_bf16_f32 v167, v206, v207
    s_waitcnt lgkmcnt(2)
    v_mfma_f32_32x32x16_bf16 v[96:111], v[176:179], v[160:163], v[96:111]
    ds_read_b128 v[192:195], v226 offset:14560
    v_mul_f32 v200, v26, v41
    v_mul_f32 v201, v27, v41
    v_mul_f32 v202, v26, v42
    v_mul_f32 v203, v27, v42
    v_mul_f32 v228, 0.5, v43
    v_mul_f32 v204, v26, v228
    v_mul_f32 v205, v27, v228
    v_mfma_f32_32x32x16_bf16 v[112:127], v[180:183], v[160:163], v[112:127]
    ds_read_b128 v[196:199], v226 offset:38480
    v_mul_f32 v206, v28, v34
    v_mul_f32 v207, v29, v34
    v_cvt_pk_bf16_f32 v168, v200, v201
    v_cvt_pk_bf16_f32 v169, v202, v203
    v_cvt_pk_bf16_f32 v170, v204, v205
    v_cvt_pk_bf16_f32 v171, v206, v207
    v_mul_f32 v200, v65, v80
    v_mfma_f32_32x32x16_bf16 v[128:143], v[176:179], v[164:167], v[128:143]
    v_mul_f32 v201, v66, v80
    v_mul_f32 v202, v65, v81
    v_mul_f32 v203, v66, v81
    v_mul_f32 v229, 0.5, v82
    v_mul_f32 v204, v65, v229
    v_mul_f32 v205, v66, v229
    v_mul_f32 v206, v67, v73
    v_mfma_f32_32x32x16_bf16 v[144:159], v[180:183], v[164:167], v[144:159]
    v_mul_f32 v207, v68, v73
    v_cvt_pk_bf16_f32 v172, v200, v201
    v_cvt_pk_bf16_f32 v173, v202, v203
    v_cvt_pk_bf16_f32 v174, v204, v205
    v_cvt_pk_bf16_f32 v175, v206, v207
    s_waitcnt lgkmcnt(2)
    v_mfma_f32_32x32x16_bf16 v[96:111], v[184:187], v[168:171], v[96:111]
    ds_read_b128 v[176:179], v226 offset:15600
    v_mul_f32 v200, v28, v35
    v_mul_f32 v201, v29, v35
    v_mul_f32 v202, v28, v36
    v_mul_f32 v203, v29, v36
    v_mul_f32 v204, v28, v37
    v_mul_f32 v205, v29, v37
    v_mfma_f32_32x32x16_bf16 v[112:127], v[188:191], v[168:171], v[112:127]
    ds_read_b128 v[180:183], v226 offset:39520
    v_mul_f32 v206, v28, v38
    v_mul_f32 v207, v29, v38
    v_cvt_pk_bf16_f32 v160, v200, v201
    v_cvt_pk_bf16_f32 v161, v202, v203
    v_cvt_pk_bf16_f32 v162, v204, v205
    v_cvt_pk_bf16_f32 v163, v206, v207
    v_mfma_f32_32x32x16_bf16 v[128:143], v[184:187], v[172:175], v[128:143]
    v_mul_f32 v200, v67, v74
    v_mul_f32 v201, v68, v74
    v_mul_f32 v202, v67, v75
    v_mul_f32 v203, v68, v75
    v_mul_f32 v204, v67, v76
    v_mul_f32 v205, v68, v76
    v_mfma_f32_32x32x16_bf16 v[144:159], v[188:191], v[172:175], v[144:159]
    v_mul_f32 v206, v67, v77
    v_mul_f32 v207, v68, v77
    v_cvt_pk_bf16_f32 v164, v200, v201
    v_cvt_pk_bf16_f32 v165, v202, v203
    v_cvt_pk_bf16_f32 v166, v204, v205
    v_cvt_pk_bf16_f32 v167, v206, v207
    s_waitcnt lgkmcnt(2)
    v_mfma_f32_32x32x16_bf16 v[96:111], v[192:195], v[160:163], v[96:111]
    ds_read_b128 v[184:187], v226 offset:16640
    v_mul_f32 v200, v28, v39
    v_mul_f32 v201, v29, v39
    v_mul_f32 v202, v28, v40
    v_mul_f32 v203, v29, v40
    v_mul_f32 v204, v28, v41
    v_mul_f32 v205, v29, v41
    v_mfma_f32_32x32x16_bf16 v[112:127], v[196:199], v[160:163], v[112:127]
    ds_read_b128 v[188:191], v226 offset:40560
    v_mul_f32 v206, v28, v42
    v_mul_f32 v207, v29, v42
    v_cvt_pk_bf16_f32 v168, v200, v201
    v_cvt_pk_bf16_f32 v169, v202, v203
    v_cvt_pk_bf16_f32 v170, v204, v205
    v_cvt_pk_bf16_f32 v171, v206, v207
    v_mfma_f32_32x32x16_bf16 v[128:143], v[192:195], v[164:167], v[128:143]
    v_mul_f32 v200, v67, v78
    v_mul_f32 v201, v68, v78
    v_mul_f32 v202, v67, v79
    v_mul_f32 v203, v68, v79
    v_mul_f32 v204, v67, v80
    v_mul_f32 v205, v68, v80
    v_mfma_f32_32x32x16_bf16 v[144:159], v[196:199], v[164:167], v[144:159]
    v_mul_f32 v206, v67, v81
    v_mul_f32 v207, v68, v81
    v_cvt_pk_bf16_f32 v172, v200, v201
    v_cvt_pk_bf16_f32 v173, v202, v203
    v_cvt_pk_bf16_f32 v174, v204, v205
    v_cvt_pk_bf16_f32 v175, v206, v207
    s_waitcnt lgkmcnt(2)
    v_mfma_f32_32x32x16_bf16 v[96:111], v[176:179], v[168:171], v[96:111]
    ds_read_b128 v[192:195], v226 offset:17680
    v_mul_f32 v200, v28, v43
    v_mul_f32 v201, v29, v43
    v_mul_f32 v228, 0.5, v44
    v_mul_f32 v202, v28, v228
    v_mul_f32 v203, v29, v228
    v_mul_f32 v204, v30, v34
    v_mul_f32 v205, v31, v34
    v_mfma_f32_32x32x16_bf16 v[112:127], v[180:183], v[168:171], v[112:127]
    ds_read_b128 v[196:199], v226 offset:41600
    v_mul_f32 v206, v30, v35
    v_mul_f32 v207, v31, v35
    v_cvt_pk_bf16_f32 v160, v200, v201
    v_cvt_pk_bf16_f32 v161, v202, v203
    v_cvt_pk_bf16_f32 v162, v204, v205
    v_cvt_pk_bf16_f32 v163, v206, v207
    v_mul_f32 v200, v67, v82
    v_mfma_f32_32x32x16_bf16 v[128:143], v[176:179], v[172:175], v[128:143]
    v_mul_f32 v201, v68, v82
    v_mul_f32 v229, 0.5, v83
    v_mul_f32 v202, v67, v229
    v_mul_f32 v203, v68, v229
    v_mul_f32 v204, v69, v73
    v_mul_f32 v205, v70, v73
    v_mul_f32 v206, v69, v74
    v_mfma_f32_32x32x16_bf16 v[144:159], v[180:183], v[172:175], v[144:159]
    v_mul_f32 v207, v70, v74
    v_cvt_pk_bf16_f32 v164, v200, v201
    v_cvt_pk_bf16_f32 v165, v202, v203
    v_cvt_pk_bf16_f32 v166, v204, v205
    v_cvt_pk_bf16_f32 v167, v206, v207
    s_waitcnt lgkmcnt(2)
    v_mfma_f32_32x32x16_bf16 v[96:111], v[184:187], v[160:163], v[96:111]
    ds_read_b128 v[176:179], v226 offset:18720
    v_mul_f32 v200, v30, v36
    v_mul_f32 v201, v31, v36
    v_mul_f32 v202, v30, v37
    v_mul_f32 v203, v31, v37
    v_mul_f32 v204, v30, v38
    v_mul_f32 v205, v31, v38
    v_mfma_f32_32x32x16_bf16 v[112:127], v[188:191], v[160:163], v[112:127]
    ds_read_b128 v[180:183], v226 offset:42640
    v_mul_f32 v206, v30, v39
    v_mul_f32 v207, v31, v39
    v_cvt_pk_bf16_f32 v168, v200, v201
    v_cvt_pk_bf16_f32 v169, v202, v203
    v_cvt_pk_bf16_f32 v170, v204, v205
    v_cvt_pk_bf16_f32 v171, v206, v207
    v_mfma_f32_32x32x16_bf16 v[128:143], v[184:187], v[164:167], v[128:143]
    v_mul_f32 v200, v69, v75
    v_mul_f32 v201, v70, v75
    v_mul_f32 v202, v69, v76
    v_mul_f32 v203, v70, v76
    v_mul_f32 v204, v69, v77
    v_mul_f32 v205, v70, v77
    v_mfma_f32_32x32x16_bf16 v[144:159], v[188:191], v[164:167], v[144:159]
    v_mul_f32 v206, v69, v78
    v_mul_f32 v207, v70, v78
    v_cvt_pk_bf16_f32 v172, v200, v201
    v_cvt_pk_bf16_f32 v173, v202, v203
    v_cvt_pk_bf16_f32 v174, v204, v205
    v_cvt_pk_bf16_f32 v175, v206, v207
    s_waitcnt lgkmcnt(2)
    v_mfma_f32_32x32x16_bf16 v[96:111], v[192:195], v[168:171], v[96:111]
    ds_read_b128 v[184:187], v226 offset:19760
    v_mul_f32 v200, v30, v40
    v_mul_f32 v201, v31, v40
    v_mul_f32 v202, v30, v41
    v_mul_f32 v203, v31, v41
    v_mul_f32 v204, v30, v42
    v_mul_f32 v205, v31, v42
    v_mfma_f32_32x32x16_bf16 v[112:127], v[196:199], v[168:171], v[112:127]
    ds_read_b128 v[188:191], v226 offset:43680
    v_mul_f32 v206, v30, v43
    v_mul_f32 v207, v31, v43
    v_cvt_pk_bf16_f32 v160, v200, v201
    v_cvt_pk_bf16_f32 v161, v202, v203
    v_cvt_pk_bf16_f32 v162, v204, v205
    v_cvt_pk_bf16_f32 v163, v206, v207
    v_mfma_f32_32x32x16_bf16 v[128:143], v[192:195], v[172:175], v[128:143]
    v_mul_f32 v200, v69, v79
    v_mul_f32 v201, v70, v79
    v_mul_f32 v202, v69, v80
    v_mul_f32 v203, v70, v80
    v_mul_f32 v204, v69, v81
    v_mul_f32 v205, v70, v81
    v_mfma_f32_32x32x16_bf16 v[144:159], v[196:199], v[172:175], v[144:159]
    v_mul_f32 v206, v69, v82
    v_mul_f32 v207, v70, v82
    v_cvt_pk_bf16_f32 v164, v200, v201
    v_cvt_pk_bf16_f32 v165, v202, v203
    v_cvt_pk_bf16_f32 v166, v204, v205
    v_cvt_pk_bf16_f32 v167, v206, v207
    s_waitcnt lgkmcnt(2)
    v_mfma_f32_32x32x16_bf16 v[96:111], v[176:179], v[160:163], v[96:111]
    ds_read_b128 v[192:195], v226 offset:20800
    v_mul_f32 v200, v30, v44
    v_mul_f32 v201, v31, v44
    v_mul_f32 v228, 0.5, v45
    v_mul_f32 v202, v30, v228
    v_mul_f32 v203, v31, v228
    v_mul_f32 v204, v32, v34
    v_mul_f32 v205, v33, v34
    v_mfma_f32_32x32x16_bf16 v[112:127], v[180:183], v[160:163], v[112:127]
    ds_read_b128 v[196:199], v226 offset:44720
    v_mul_f32 v206, v32, v35
    v_mul_f32 v207, v33, v35
    v_cvt_pk_bf16_f32 v168, v200, v201
    v_cvt_pk_bf16_f32 v169, v202, v203
    v_cvt_pk_bf16_f32 v170, v204, v205
    v_cvt_pk_bf16_f32 v171, v206, v207
    v_mul_f32 v200, v69, v83
    v_mfma_f32_32x32x16_bf16 v[128:143], v[176:179], v[164:167], v[128:143]
    v_mul_f32 v201, v70, v83
    v_mul_f32 v229, 0.5, v84
    v_mul_f32 v202, v69, v229
    v_mul_f32 v203, v70, v229
    v_mul_f32 v204, v71, v73
    v_mul_f32 v205, v72, v73
    v_mul_f32 v206, v71, v74
    v_mfma_f32_32x32x16_bf16 v[144:159], v[180:183], v[164:167], v[144:159]
    v_mul_f32 v207, v72, v74
    v_cvt_pk_bf16_f32 v172, v200, v201
    v_cvt_pk_bf16_f32 v173, v202, v203
    v_cvt_pk_bf16_f32 v174, v204, v205
    v_cvt_pk_bf16_f32 v175, v206, v207
    s_waitcnt lgkmcnt(2)
    v_mfma_f32_32x32x16_bf16 v[96:111], v[184:187], v[168:171], v[96:111]
    ds_read_b128 v[176:179], v226 offset:21840
    v_mul_f32 v200, v32, v36
    v_mul_f32 v201, v33, v36
    v_mul_f32 v202, v32, v37
    v_mul_f32 v203, v33, v37
    v_mul_f32 v204, v32, v38
    v_mul_f32 v205, v33, v38
    v_mfma_f32_32x32x16_bf16 v[112:127], v[188:191], v[168:171], v[112:127]
    ds_read_b128 v[180:183], v226 offset:45760
    v_mul_f32 v206, v32, v39
    v_mul_f32 v207, v33, v39
    v_cvt_pk_bf16_f32 v160, v200, v201
    v_cvt_pk_bf16_f32 v161, v202, v203
    v_cvt_pk_bf16_f32 v162, v204, v205
    v_cvt_pk_bf16_f32 v163, v206, v207
    v_mfma_f32_32x32x16_bf16 v[128:143], v[184:187], v[172:175], v[128:143]
    v_mul_f32 v200, v71, v75
    v_mul_f32 v201, v72, v75
    v_mul_f32 v202, v71, v76
    v_mul_f32 v203, v72, v76
    v_mul_f32 v204, v71, v77
    v_mul_f32 v205, v72, v77
    v_mfma_f32_32x32x16_bf16 v[144:159], v[188:191], v[172:175], v[144:159]
    v_mul_f32 v206, v71, v78
    v_mul_f32 v207, v72, v78
    v_cvt_pk_bf16_f32 v164, v200, v201
    v_cvt_pk_bf16_f32 v165, v202, v203
    v_cvt_pk_bf16_f32 v166, v204, v205
    v_cvt_pk_bf16_f32 v167, v206, v207
    s_waitcnt lgkmcnt(2)
    v_mfma_f32_32x32x16_bf16 v[96:111], v[192:195], v[160:163], v[96:111]
    ds_read_b128 v[184:187], v226 offset:22880
    v_mul_f32 v200, v32, v40
    v_mul_f32 v201, v33, v40
    v_mul_f32 v202, v32, v41
    v_mul_f32 v203, v33, v41
    v_mul_f32 v204, v32, v42
    v_mul_f32 v205, v33, v42
    v_mfma_f32_32x32x16_bf16 v[112:127], v[196:199], v[160:163], v[112:127]
    ds_read_b128 v[188:191], v226 offset:46800
    v_mul_f32 v206, v32, v43
    v_mul_f32 v207, v33, v43
    v_cvt_pk_bf16_f32 v168, v200, v201
    v_cvt_pk_bf16_f32 v169, v202, v203
    v_cvt_pk_bf16_f32 v170, v204, v205
    v_cvt_pk_bf16_f32 v171, v206, v207
    v_mfma_f32_32x32x16_bf16 v[128:143], v[192:195], v[164:167], v[128:143]
    v_mul_f32 v200, v71, v79
    v_mul_f32 v201, v72, v79
    v_mul_f32 v202, v71, v80
    v_mul_f32 v203, v72, v80
    v_mul_f32 v204, v71, v81
    v_mul_f32 v205, v72, v81
    v_mfma_f32_32x32x16_bf16 v[144:159], v[196:199], v[164:167], v[144:159]
    v_mul_f32 v206, v71, v82
    v_mul_f32 v207, v72, v82
    v_cvt_pk_bf16_f32 v172, v200, v201
    v_cvt_pk_bf16_f32 v173, v202, v203
    v_cvt_pk_bf16_f32 v174, v204, v205
    v_cvt_pk_bf16_f32 v175, v206, v207
    s_waitcnt lgkmcnt(2)
    v_mfma_f32_32x32x16_bf16 v[96:111], v[176:179], v[168:171], v[96:111]
    ds_read_b128 v[196:199], v226 offset:47840
    v_mul_f32 v200, v32, v44
    v_mul_f32 v201, v33, v44
    v_mul_f32 v202, v32, v45
    v_mul_f32 v203, v33, v45
    v_mul_f32 v228, 0.5, v46
    v_mul_f32 v204, v32, v228
    v_mfma_f32_32x32x16_bf16 v[112:127], v[180:183], v[168:171], v[112:127]
    v_mul_f32 v205, v33, v228
    v_cvt_pk_bf16_f32 v160, v200, v201
    v_cvt_pk_bf16_f32 v161, v202, v203
    v_cvt_pk_bf16_f32 v162, v204, v205
    v_cvt_pk_bf16_f32 v163, v34, 0
    v_mul_f32 v200, v71, v83
    v_mfma_f32_32x32x16_bf16 v[128:143], v[176:179], v[172:175], v[128:143]
    v_mul_f32 v201, v72, v83
    v_mul_f32 v202, v71, v84
    v_mul_f32 v203, v72, v84
    v_mul_f32 v229, 0.5, v85
    v_mul_f32 v204, v71, v229
    v_mul_f32 v205, v72, v229
    v_mfma_f32_32x32x16_bf16 v[144:159], v[180:183], v[172:175], v[144:159]
    v_cvt_pk_bf16_f32 v164, v200, v201
    v_cvt_pk_bf16_f32 v165, v202, v203
    v_cvt_pk_bf16_f32 v166, v204, v205
    v_cvt_pk_bf16_f32 v167, v73, 0
    s_waitcnt lgkmcnt(1)
    v_mfma_f32_32x32x16_bf16 v[96:111], v[184:187], v[160:163], v[96:111]
    ds_read_b128 v[180:183], v226 offset:48880
    v_cvt_pk_bf16_f32 v168, v35, 0
    v_cvt_pk_bf16_f32 v169, v36, 0
    v_mfma_f32_32x32x16_bf16 v[112:127], v[188:191], v[160:163], v[112:127]
    v_cvt_pk_bf16_f32 v170, v37, 0
    v_cvt_pk_bf16_f32 v171, v38, 0
    v_mfma_f32_32x32x16_bf16 v[128:143], v[184:187], v[164:167], v[128:143]
    v_cvt_pk_bf16_f32 v172, v74, 0
    v_cvt_pk_bf16_f32 v173, v75, 0
    v_mfma_f32_32x32x16_bf16 v[144:159], v[188:191], v[164:167], v[144:159]
    v_cvt_pk_bf16_f32 v174, v76, 0
    v_cvt_pk_bf16_f32 v175, v77, 0
    s_waitcnt lgkmcnt(1)
    v_mfma_f32_32x32x16_bf16 v[112:127], v[196:199], v[168:171], v[112:127]
    ds_read_b128 v[188:191], v226 offset:49920
    v_cvt_pk_bf16_f32 v160, v39, 0
    v_cvt_pk_bf16_f32 v161, v40, 0
    v_cvt_pk_bf16_f32 v162, v41, 0
    v_cvt_pk_bf16_f32 v163, v42, 0
    v_mfma_f32_32x32x16_bf16 v[144:159], v[196:199], v[172:175], v[144:159]
    v_cvt_pk_bf16_f32 v164, v78, 0
    v_cvt_pk_bf16_f32 v165, v79, 0
    v_cvt_pk_bf16_f32 v166, v80, 0
    v_cvt_pk_bf16_f32 v167, v81, 0
    s_waitcnt lgkmcnt(1)
    v_mfma_f32_32x32x16_bf16 v[112:127], v[180:183], v[160:163], v[112:127]
    v_cvt_pk_bf16_f32 v168, v43, 0
    v_cvt_pk_bf16_f32 v169, v44, 0
    v_cvt_pk_bf16_f32 v170, v45, 0
    v_cvt_pk_bf16_f32 v171, v46, 0
    v_mfma_f32_32x32x16_bf16 v[144:159], v[180:183], v[164:167], v[144:159]
    v_cvt_pk_bf16_f32 v172, v82, 0
    v_cvt_pk_bf16_f32 v173, v83, 0
    v_cvt_pk_bf16_f32 v174, v84, 0
    v_cvt_pk_bf16_f32 v175, v85, 0
    s_waitcnt lgkmcnt(0)
    v_mfma_f32_32x32x16_bf16 v[112:127], v[188:191], v[168:171], v[112:127]
    v_mfma_f32_32x32x16_bf16 v[144:159], v[188:191], v[172:175], v[144:159]
    s_nop 15
    v_mul_f32 v200, v96, v112
    v_mul_f32 v201, v128, v144
    v_fmac_f32 v200, v97, v113
    v_fmac_f32 v201, v129, v145
    v_fmac_f32 v200, v98, v114
    v_fmac_f32 v201, v130, v146
    v_fmac_f32 v200, v99, v115
    v_fmac_f32 v201, v131, v147
    v_fmac_f32 v200, v100, v116
    v_fmac_f32 v201, v132, v148
    v_fmac_f32 v200, v101, v117
    v_fmac_f32 v201, v133, v149
    v_fmac_f32 v200, v102, v118
    v_fmac_f32 v201, v134, v150
    v_fmac_f32 v200, v103, v119
    v_fmac_f32 v201, v135, v151
    v_fmac_f32 v200, v104, v120
    v_fmac_f32 v201, v136, v152
    v_fmac_f32 v200, v105, v121
    v_fmac_f32 v201, v137, v153
    v_fmac_f32 v200, v106, v122
    v_fmac_f32 v201, v138, v154
    v_fmac_f32 v200, v107, v123
    v_fmac_f32 v201, v139, v155
    v_fmac_f32 v200, v108, v124
    v_fmac_f32 v201, v140, v156
    v_fmac_f32 v200, v109, v125
    v_fmac_f32 v201, v141, v157
    s_nop 1
    v_add_f32_dpp v200, v200, v200 row_ror:8 row_mask:0xf bank_mask:0xf
    v_add_f32_dpp v201, v201, v201 row_ror:8 row_mask:0xf bank_mask:0xf
    s_nop 1
    v_add_f32_dpp v200, v200, v200 row_ror:4 row_mask:0xf bank_mask:0xf
    v_add_f32_dpp v201, v201, v201 row_ror:4 row_mask:0xf bank_mask:0xf
    s_nop 1
    v_add_f32_dpp v200, v200, v200 row_ror:2 row_mask:0xf bank_mask:0xf
    v_add_f32_dpp v201, v201, v201 row_ror:2 row_mask:0xf bank_mask:0xf
    s_nop 1
    v_add_f32_dpp v200, v200, v200 row_ror:1 row_mask:0xf bank_mask:0xf
    v_add_f32_dpp v201, v201, v201 row_ror:1 row_mask:0xf bank_mask:0xf
    v_bfe_u32 v202, v1, 4, 1
    v_lshlrev_b32 v202, 3, v202
    v_lshrrev_b32 v203, 5, v1
    v_lshl_add_u32 v202, v203, 2, v202
    s_lshl_b32 s63, s66, 5
    s_add_u32 s63, s63, 163456
    v_add_u32 v202, s63, v202
    ds_write_b32 v202, v200
    ds_write_b32 v202, v201 offset:16
    s_branch L_final
L_D:
    s_mov_b32 s28, s6
    s_mov_b32 s29, s7
    s_mov_b32 s30, 3200000
    s_mov_b32 s31, 0x20000
    s_mov_b32 s36, s12
    s_mov_b32 s37, s13
    s_mov_b32 s38, 346112
    s_mov_b32 s39, 0x20000
    s_mov_b32 s32, s8
    s_mov_b32 s33, s9
    s_mov_b32 s34, 105456
    s_mov_b32 s35, 0x20000
    s_mul_i32 s81, s66, 224
    s_mul_i32 s63, s66, 192
    s_add_u32 s63, s63, 64
    s_mul_i32 s67, s66, 7168
    s_mul_i32 s64, s66, 6144
    s_add_u32 s64, s64, 2048
    s_cmp_lt_u32 s66, 2
    s_cselect_b32 s81, s81, s63
    s_cselect_b32 s67, s67, s64
    s_cselect_b32 s79, 7, 6
    s_movk_i32 s74, 5462
    s_cselect_b32 s74, 4682, s74
    s_cselect_b32 s75, 14, 12
    s_movk_i32 s78, 192
    s_cselect_b32 s78, 224, s78
    s_cselect_b32 s76, -1, 0
    s_add_u32 s67, s67, 59072
    s_mov_b64 exec, 0xffff
    s_mov_b32 s68, s14
    s_mov_b32 s69, s15
    s_mov_b32 s70, 832
    s_mov_b32 s71, 0x20000
    s_add_u32 m0, s67, 0
    s_nop 0
    buffer_load_dwordx4 v26, s[68:71], s81 offen lds
    s_mov_b32 s68, s16
    s_mov_b32 s69, s17
    s_mov_b32 s70, 832
    s_mov_b32 s71, 0x20000
    s_add_u32 m0, s67, 256
    s_nop 0
    buffer_load_dwordx4 v26, s[68:71], s81 offen lds
    s_mov_b64 exec, -1
    s_lshl_b32 s73, s66, 10
    s_add_u32 s72, s73, 70304
    s_add_u32 s73, s73, 23920
    s_mov_b32 m0, s73
    s_add_u32 s73, s73, 4096
    buffer_load_dwordx4 v26, s[32:35], s72 offen lds
    s_add_u32 s72, s72, 4096
    s_mov_b32 m0, s73
    s_add_u32 s73, s73, 4096
    buffer_load_dwordx4 v26, s[32:35], s72 offen lds
    s_add_u32 s72, s72, 4096
    s_mov_b32 m0, s73
    s_add_u32 s73, s73, 4096
    buffer_load_dwordx4 v26, s[32:35], s72 offen lds
    s_add_u32 s72, s72, 4096
    s_mov_b32 m0, s73
    s_add_u32 s73, s73, 4096
    buffer_load_dwordx4 v26, s[32:35], s72 offen lds
    s_add_u32 s72, s72, 4096
    s_mov_b32 m0, s73
    s_add_u32 s73, s73, 4096
    buffer_load_dwordx4 v26, s[32:35], s72 offen lds
    s_add_u32 s72, s72, 4096
    s_mov_b32 m0, s73
    s_add_u32 s73, s73, 4096
    buffer_load_dwordx4 v26, s[32:35], s72 offen lds
    s_add_u32 s72, s72, 4096
    s_mov_b32 m0, s73
    s_add_u32 s73, s73, 4096
    buffer_load_dwordx4 v26, s[32:35], s72 offen lds
    s_add_u32 s72, s72, 4096
    s_mov_b32 m0, s73
    s_add_u32 s73, s73, 4096
    buffer_load_dwordx4 v26, s[32:35], s72 offen lds
    s_add_u32 s72, s72, 4096
    s_cmp_lt_u32 s66, 2
    s_cbranch_scc1 L_lin1
    s_mov_b64 exec, 0x1fffff
    s_cmp_eq_u32 s66, 2
    s_cbranch_scc1 L_lin1
    s_mov_b32 s72, 268435456
    s_mov_b32 s73, 196608
L_lin1:
    s_mov_b32 m0, s73
    s_nop 0
    buffer_load_dwordx4 v26, s[32:35], s72 offen lds
    s_mov_b64 exec, -1
    v_and_b32 v8, 1, v1
    v_lshlrev_b32 v8, 4, v8
    v_mul_u32_u24 v15, 52, v2
    v_lshl_add_u32 v27, v3, 4, v15
    v_add_u32 v9, 0, v1
    v_mul_u32_u24 v10, s74, v9
    v_lshrrev_b32 v10, 16, v10
    v_mul_u32_u24 v11, s75, v10
    v_sub_u32 v11, v9, v11
    v_lshrrev_b32 v12, 1, v11
    v_bfe_u32 v13, v10, 3, 1
    v_xor_b32 v14, v12, v13
    v_add_u32 v15, 3, v12
    v_cmp_lt_u32 vcc, 6, v15
    v_subrev_u32 v9, 7, v15
    v_and_b32 v11, 1, v11
    v_cndmask_b32 v15, v15, v9, vcc
    v_cmp_eq_u32 vcc, 1, v13
    v_mul_u32_u24 v10, 832, v10
    v_add_u32 v10, s81, v10
    v_cndmask_b32 v15, v12, v15, vcc
    v_and_b32 v15, s76, v15
    v_not_b32 v9, s76
    v_and_b32 v14, v9, v14
    v_or_b32 v15, v15, v14
    v_lshl_add_u32 v11, v15, 1, v11
    v_lshl_add_u32 v11, v11, 4, v10
    v_mov_b32 v16, v11
    v_add_u32 v9, 64, v1
    v_mul_u32_u24 v10, s74, v9
    v_lshrrev_b32 v10, 16, v10
    v_mul_u32_u24 v11, s75, v10
    v_sub_u32 v11, v9, v11
    v_lshrrev_b32 v12, 1, v11
    v_bfe_u32 v13, v10, 3, 1
    v_xor_b32 v14, v12, v13
    v_add_u32 v15, 3, v12
    v_cmp_lt_u32 vcc, 6, v15
    v_subrev_u32 v9, 7, v15
    v_and_b32 v11, 1, v11
    v_cndmask_b32 v15, v15, v9, vcc
    v_cmp_eq_u32 vcc, 1, v13
    v_mul_u32_u24 v10, 832, v10
    v_add_u32 v10, s81, v10
    v_cndmask_b32 v15, v12, v15, vcc
    v_and_b32 v15, s76, v15
    v_not_b32 v9, s76
    v_and_b32 v14, v9, v14
    v_or_b32 v15, v15, v14
    v_lshl_add_u32 v11, v15, 1, v11
    v_lshl_add_u32 v11, v11, 4, v10
    v_subrev_u32 v17, 1024, v11
    v_add_u32 v9, 128, v1
    v_mul_u32_u24 v10, s74, v9
    v_lshrrev_b32 v10, 16, v10
    v_mul_u32_u24 v11, s75, v10
    v_sub_u32 v11, v9, v11
    v_lshrrev_b32 v12, 1, v11
    v_bfe_u32 v13, v10, 3, 1
    v_xor_b32 v14, v12, v13
    v_add_u32 v15, 3, v12
    v_cmp_lt_u32 vcc, 6, v15
    v_subrev_u32 v9, 7, v15
    v_and_b32 v11, 1, v11
    v_cndmask_b32 v15, v15, v9, vcc
    v_cmp_eq_u32 vcc, 1, v13
    v_mul_u32_u24 v10, 832, v10
    v_add_u32 v10, s81, v10
    v_cndmask_b32 v15, v12, v15, vcc
    v_and_b32 v15, s76, v15
    v_not_b32 v9, s76
    v_and_b32 v14, v9, v14
    v_or_b32 v15, v15, v14
    v_lshl_add_u32 v11, v15, 1, v11
    v_lshl_add_u32 v11, v11, 4, v10
    v_subrev_u32 v18, 2048, v11
    v_add_u32 v9, 192, v1
    v_mul_u32_u24 v10, s74, v9
    v_lshrrev_b32 v10, 16, v10
    v_mul_u32_u24 v11, s75, v10
    v_sub_u32 v11, v9, v11
    v_lshrrev_b32 v12, 1, v11
    v_bfe_u32 v13, v10, 3, 1
    v_xor_b32 v14, v12, v13
    v_add_u32 v15, 3, v12
    v_cmp_lt_u32 vcc, 6, v15
    v_subrev_u32 v9, 7, v15
    v_and_b32 v11, 1, v11
    v_cndmask_b32 v15, v15, v9, vcc
    v_cmp_eq_u32 vcc, 1, v13
    v_mul_u32_u24 v10, 832, v10
    v_add_u32 v10, s81, v10
    v_cndmask_b32 v15, v12, v15, vcc
    v_and_b32 v15, s76, v15
    v_not_b32 v9, s76
    v_and_b32 v14, v9, v14
    v_or_b32 v15, v15, v14
    v_lshl_add_u32 v11, v15, 1, v11
    v_lshl_add_u32 v11, v11, 4, v10
    v_subrev_u32 v19, 3072, v11
    v_add_u32 v9, 256, v1
    v_mul_u32_u24 v10, s74, v9
    v_lshrrev_b32 v10, 16, v10
    v_mul_u32_u24 v11, s75, v10
    v_sub_u32 v11, v9, v11
    v_lshrrev_b32 v12, 1, v11
    v_bfe_u32 v13, v10, 3, 1
    v_xor_b32 v14, v12, v13
    v_add_u32 v15, 3, v12
    v_cmp_lt_u32 vcc, 6, v15
    v_subrev_u32 v9, 7, v15
    v_and_b32 v11, 1, v11
    v_cndmask_b32 v15, v15, v9, vcc
    v_cmp_eq_u32 vcc, 1, v13
    v_mul_u32_u24 v10, 832, v10
    v_add_u32 v10, s81, v10
    v_cndmask_b32 v15, v12, v15, vcc
    v_and_b32 v15, s76, v15
    v_not_b32 v9, s76
    v_and_b32 v14, v9, v14
    v_or_b32 v15, v15, v14
    v_lshl_add_u32 v11, v15, 1, v11
    v_lshl_add_u32 v11, v11, 4, v10
    v_mov_b32 v20, v11
    v_add_u32 v9, 320, v1
    v_mul_u32_u24 v10, s74, v9
    v_lshrrev_b32 v10, 16, v10
    v_mul_u32_u24 v11, s75, v10
    v_sub_u32 v11, v9, v11
    v_lshrrev_b32 v12, 1, v11
    v_bfe_u32 v13, v10, 3, 1
    v_xor_b32 v14, v12, v13
    v_add_u32 v15, 3, v12
    v_cmp_lt_u32 vcc, 6, v15
    v_subrev_u32 v9, 7, v15
    v_and_b32 v11, 1, v11
    v_cndmask_b32 v15, v15, v9, vcc
    v_cmp_eq_u32 vcc, 1, v13
    v_mul_u32_u24 v10, 832, v10
    v_add_u32 v10, s81, v10
    v_cndmask_b32 v15, v12, v15, vcc
    v_and_b32 v15, s76, v15
    v_not_b32 v9, s76
    v_and_b32 v14, v9, v14
    v_or_b32 v15, v15, v14
    v_lshl_add_u32 v11, v15, 1, v11
    v_lshl_add_u32 v11, v11, 4, v10
    v_subrev_u32 v21, 1024, v11
    v_add_u32 v9, 384, v1
    v_mul_u32_u24 v10, s74, v9
    v_lshrrev_b32 v10, 16, v10
    v_mul_u32_u24 v11, s75, v10
    v_sub_u32 v11, v9, v11
    v_lshrrev_b32 v12, 1, v11
    v_bfe_u32 v13, v10, 3, 1
    v_xor_b32 v14, v12, v13
    v_add_u32 v15, 3, v12
    v_cmp_lt_u32 vcc, 6, v15
    v_subrev_u32 v9, 7, v15
    v_and_b32 v11, 1, v11
    v_cndmask_b32 v15, v15, v9, vcc
    v_cmp_eq_u32 vcc, 1, v13
    v_mul_u32_u24 v10, 832, v10
    v_add_u32 v10, s81, v10
    v_cndmask_b32 v15, v12, v15, vcc
    v_and_b32 v15, s76, v15
    v_not_b32 v9, s76
    v_and_b32 v14, v9, v14
    v_or_b32 v15, v15, v14
    v_lshl_add_u32 v11, v15, 1, v11
    v_lshl_add_u32 v11, v11, 4, v10
    v_subrev_u32 v22, 2048, v11
    v_lshrrev_b32 v10, 2, v2
    v_lshl_add_u32 v11, v3, 3, v10
    v_mul_u32_u24 v11, s78, v11
    v_and_b32 v12, 3, v2
    v_lshl_add_u32 v11, v12, 3, v11
    v_add_u32 v11, s67, v11
    v_and_b32 v12, 1, v3
    v_cmp_eq_u32 vcc, 1, v12
    v_not_b32 v14, s76
    v_mov_b32 v13, 0
    v_mov_b32 v15, 4
    v_xor_b32 v10, 0, v12
    v_cndmask_b32 v13, v13, v15, vcc
    v_and_b32 v13, s76, v13
    v_and_b32 v10, v14, v10
    v_or_b32 v13, v13, v10
    v_lshl_add_u32 v136, v13, 5, v11
    v_mov_b32 v13, 1
    v_mov_b32 v15, 5
    v_xor_b32 v10, 1, v12
    v_cndmask_b32 v13, v13, v15, vcc
    v_and_b32 v13, s76, v13
    v_and_b32 v10, v14, v10
    v_or_b32 v13, v13, v10
    v_lshl_add_u32 v137, v13, 5, v11
    v_mov_b32 v13, 2
    v_mov_b32 v15, 6
    v_xor_b32 v10, 2, v12
    v_cndmask_b32 v13, v13, v15, vcc
    v_and_b32 v13, s76, v13
    v_and_b32 v10, v14, v10
    v_or_b32 v13, v13, v10
    v_lshl_add_u32 v138, v13, 5, v11
    v_mov_b32 v13, 3
    v_mov_b32 v15, 0
    v_xor_b32 v10, 3, v12
    v_cndmask_b32 v13, v13, v15, vcc
    v_and_b32 v13, s76, v13
    v_and_b32 v10, v14, v10
    v_or_b32 v13, v13, v10
    v_lshl_add_u32 v139, v13, 5, v11
    v_mov_b32 v13, 4
    v_mov_b32 v15, 1
    v_xor_b32 v10, 4, v12
    v_cndmask_b32 v13, v13, v15, vcc
    v_and_b32 v13, s76, v13
    v_and_b32 v10, v14, v10
    v_or_b32 v13, v13, v10
    v_lshl_add_u32 v140, v13, 5, v11
    v_mov_b32 v13, 5
    v_mov_b32 v15, 2
    v_xor_b32 v10, 5, v12
    v_cndmask_b32 v13, v13, v15, vcc
    v_and_b32 v13, s76, v13
    v_and_b32 v10, v14, v10
    v_or_b32 v13, v13, v10
    v_lshl_add_u32 v141, v13, 5, v11
    v_mov_b32 v13, 6
    v_mov_b32 v15, 3
    v_xor_b32 v10, 6, v12
    v_cndmask_b32 v13, v13, v15, vcc
    v_and_b32 v13, s76, v13
    v_and_b32 v10, v14, v10
    v_or_b32 v13, v13, v10
    v_lshl_add_u32 v142, v13, 5, v11
    v_mul_u32_u24 v185, 832, v2
    v_lshl_add_u32 v185, v3, 4, v185
    v_add_u32 v185, 150016, v185
    s_mov_b32 s80, 0
    s_lshl_b32 s73, s66, 10
    s_add_u32 s72, s73, 35152
    s_add_u32 s73, s73, 112816
    s_mov_b32 m0, s73
    s_add_u32 s73, s73, 4096
    buffer_load_dwordx4 v26, s[32:35], s72 offen lds
    s_add_u32 s72, s72, 4096
    s_mov_b32 m0, s73
    s_add_u32 s73, s73, 4096
    buffer_load_dwordx4 v26, s[32:35], s72 offen lds
    s_add_u32 s72, s72, 4096
    s_mov_b32 m0, s73
    s_add_u32 s73, s73, 4096
    buffer_load_dwordx4 v26, s[32:35], s72 offen lds
    s_add_u32 s72, s72, 4096
    s_mov_b32 m0, s73
    s_add_u32 s73, s73, 4096
    buffer_load_dwordx4 v26, s[32:35], s72 offen lds
    s_add_u32 s72, s72, 4096
    s_mov_b32 m0, s73
    s_add_u32 s73, s73, 4096
    buffer_load_dwordx4 v26, s[32:35], s72 offen lds
    s_add_u32 s72, s72, 4096
    s_mov_b32 m0, s73
    s_add_u32 s73, s73, 4096
    buffer_load_dwordx4 v26, s[32:35], s72 offen lds
    s_add_u32 s72, s72, 4096
    s_mov_b32 m0, s73
    s_add_u32 s73, s73, 4096
    buffer_load_dwordx4 v26, s[32:35], s72 offen lds
    s_add_u32 s72, s72, 4096
    s_mov_b32 m0, s73
    s_add_u32 s73, s73, 4096
    buffer_load_dwordx4 v26, s[32:35], s72 offen lds
    s_add_u32 s72, s72, 4096
    s_cmp_lt_u32 s66, 2
    s_cbranch_scc1 L_lin2
    s_mov_b64 exec, 0x1fffff
    s_cmp_eq_u32 s66, 2
    s_cbranch_scc1 L_lin2
    s_mov_b32 s72, 268435456
    s_mov_b32 s73, 196608
L_lin2:
    s_mov_b32 m0, s73
    s_nop 0
    buffer_load_dwordx4 v26, s[32:35], s72 offen lds
    s_mov_b64 exec, -1
    s_waitcnt vmcnt(9)
    s_barrier
    s_mul_i32 s63, s66, 1352
    buffer_load_dwordx4 v[64:67], v27, s[32:35], s63 offen
    buffer_load_dwordx4 v[68:71], v27, s[32:35], s63 offen offset:832
    s_add_u32 s63, s63, 5408
    buffer_load_dwordx4 v[72:75], v27, s[32:35], s63 offen
    buffer_load_dwordx4 v[76:79], v27, s[32:35], s63 offen offset:832
    s_add_u32 s63, s63, 5408
    buffer_load_dwordx4 v[80:83], v27, s[32:35], s63 offen
    buffer_load_dwordx4 v[84:87], v27, s[32:35], s63 offen offset:832
    s_add_u32 s63, s63, 5408
    buffer_load_dwordx4 v[88:91], v27, s[32:35], s63 offen
    buffer_load_dwordx4 v[92:95], v27, s[32:35], s63 offen offset:832
    s_add_u32 s63, s63, 5408
    buffer_load_dwordx4 v[96:99], v27, s[32:35], s63 offen
    buffer_load_dwordx4 v[100:103], v27, s[32:35], s63 offen offset:832
    s_add_u32 s63, s63, 5408
    buffer_load_dwordx4 v[104:107], v27, s[32:35], s63 offen
    buffer_load_dwordx4 v[108:111], v27, s[32:35], s63 offen offset:832
    s_add_u32 s63, s63, 5408
    s_cmp_lt_u32 s66, 2
    s_cselect_b32 s63, s63, 268435456
    buffer_load_dwordx4 v[112:115], v27, s[32:35], s63 offen
    buffer_load_dwordx4 v[116:119], v27, s[32:35], s63 offen offset:832
    s_waitcnt vmcnt(14)
    s_barrier
    v_lshl_add_u32 v4, v4, 5, v8
    v_lshl_add_u32 v5, v5, 5, v8
    v_lshl_add_u32 v6, v6, 5, v8
    v_lshl_add_u32 v7, v7, 5, v8
    s_mul_i32 s63, s66, 3328
    s_add_u32 s63, s63, 150016
    s_mov_b32 exec_lo, -1
    s_mov_b32 exec_hi, 0xfffff
    s_add_u32 m0, s63, 0
    s_nop 0
    buffer_load_dwordx4 v4, s[28:31], 0 offen lds
    s_add_u32 m0, s63, 832
    s_nop 0
    buffer_load_dwordx4 v5, s[28:31], 0 offen lds
    s_add_u32 m0, s63, 1664
    s_nop 0
    buffer_load_dwordx4 v6, s[28:31], 0 offen lds
    s_add_u32 m0, s63, 2496
    s_nop 0
    buffer_load_dwordx4 v7, s[28:31], 0 offen lds
    s_mov_b64 exec, -1
    v_lshlrev_b32 v9, 1, v2
    v_add_u32 v9, s67, v9
    v_mov_b32 v152, 0
    v_mov_b32 v144, 0
    v_mov_b32 v153, 0
    v_mov_b32 v145, 0
    v_mov_b32 v154, 0
    v_mov_b32 v146, 0
    v_mov_b32 v155, 0
    v_mov_b32 v147, 0
    v_mov_b32 v156, 0
    v_mov_b32 v148, 0
    v_mov_b32 v157, 0
    v_mov_b32 v149, 0
    v_mov_b32 v158, 0
    v_mov_b32 v150, 0
    ds_read_u16_d16_hi v152, v9 offset:0
    ds_read_u16_d16_hi v144, v9 offset:256
    ds_read_u16_d16_hi v153, v9 offset:32
    ds_read_u16_d16_hi v145, v9 offset:288
    ds_read_u16_d16_hi v154, v9 offset:64
    ds_read_u16_d16_hi v146, v9 offset:320
    ds_read_u16_d16_hi v155, v9 offset:96
    ds_read_u16_d16_hi v147, v9 offset:352
    ds_read_u16_d16_hi v156, v9 offset:128
    ds_read_u16_d16_hi v148, v9 offset:384
    ds_read_u16_d16_hi v157, v9 offset:160
    ds_read_u16_d16_hi v149, v9 offset:416
    ds_read_u16_d16_hi v158, v9 offset:192
    ds_read_u16_d16_hi v150, v9 offset:448
    s_waitcnt lgkmcnt(0)
    v_mov_b32 v32, v152
    v_mov_b32 v33, v152
    v_mov_b32 v34, v152
    v_mov_b32 v35, v152
    v_mov_b32 v36, v153
    v_mov_b32 v37, v153
    v_mov_b32 v38, v153
    v_mov_b32 v39, v153
    v_mov_b32 v40, v154
    v_mov_b32 v41, v154
    v_mov_b32 v42, v154
    v_mov_b32 v43, v154
    v_mov_b32 v44, v155
    v_mov_b32 v45, v155
    v_mov_b32 v46, v155
    v_mov_b32 v47, v155
    v_mov_b32 v48, v156
    v_mov_b32 v49, v156
    v_mov_b32 v50, v156
    v_mov_b32 v51, v156
    v_mov_b32 v52, v157
    v_mov_b32 v53, v157
    v_mov_b32 v54, v157
    v_mov_b32 v55, v157
    v_mov_b32 v56, v158
    v_mov_b32 v57, v158
    v_mov_b32 v58, v158
    v_mov_b32 v59, v158
    v_lshlrev_b32 v12, 3, v3
    v_sub_u32 v12, v2, v12
    v_and_b32 v13, 1, v12
    v_lshlrev_b32 v13, 4, v13
    v_mov_b32 v14, 0x3f80
    v_lshlrev_b32 v13, v13, v14
    v_ashrrev_i32 v12, 1, v12
    v_add_u32 v14, 8, v12
    v_cmp_eq_u32 s[88:89], 0, v12
    v_cmp_eq_u32 s[90:91], 1, v12
    v_cmp_eq_u32 s[92:93], 2, v12
    v_cmp_eq_u32 s[94:95], 3, v12
    v_cndmask_b32 v120, 0, v13, s[88:89]
    v_cndmask_b32 v121, 0, v13, s[90:91]
    v_cndmask_b32 v122, 0, v13, s[92:93]
    v_cndmask_b32 v123, 0, v13, s[94:95]
    v_cmp_eq_u32 s[88:89], 0, v14
    v_cmp_eq_u32 s[90:91], 1, v14
    v_cmp_eq_u32 s[92:93], 2, v14
    v_cmp_eq_u32 s[94:95], 3, v14
    v_cndmask_b32 v124, 0, v13, s[88:89]
    v_cndmask_b32 v125, 0, v13, s[90:91]
    v_cndmask_b32 v126, 0, v13, s[92:93]
    v_cndmask_b32 v127, 0, v13, s[94:95]
    v_lshlrev_b32 v198, 1, v3
    v_lshrrev_b32 v199, 1, v2
    v_and_b32 v200, 1, v2
    v_mul_u32_u24 v200, 528, v200
    s_lshl_b32 s65, s66, 4
    v_add_u32 v200, s65, v200
    v_add_u32 v205, 0, v198
    v_mad_i32_i24 v202, v205, v205, v205
    v_lshrrev_b32 v202, 1, v202
    v_add3_u32 v202, v202, v199, 0
    v_min_u32 v204, 12, v205
    v_cmp_ge_u32 s[88:89], 12, v205
    v_add_u32 v201, 0, v199
    v_and_b32 v203, 0x7c, v202
    v_cmp_le_u32 s[90:91], v201, v204
    v_lshlrev_b32 v203, 8, v203
    v_lshl_add_u32 v203, v202, 2, v203
    s_and_b64 s[88:89], s[88:89], s[90:91]
    v_add_u32 v203, v203, v200
    v_cndmask_b32 v192, v24, v203, s[88:89]
    v_add_u32 v205, 1, v198
    v_mad_i32_i24 v202, v205, v205, v205
    v_lshrrev_b32 v202, 1, v202
    v_add3_u32 v202, v202, v199, 0
    v_min_u32 v204, 12, v205
    v_cmp_ge_u32 s[92:93], 12, v205
    v_add_u32 v201, 0, v199
    v_and_b32 v203, 0x7c, v202
    v_cmp_le_u32 s[94:95], v201, v204
    v_lshlrev_b32 v203, 8, v203
    v_lshl_add_u32 v203, v202, 2, v203
    s_and_b64 s[92:93], s[92:93], s[94:95]
    v_add_u32 v203, v203, v200
    v_cndmask_b32 v193, v24, v203, s[92:93]
    v_add_u32 v205, 8, v198
    v_mad_i32_i24 v202, v205, v205, v205
    v_lshrrev_b32 v202, 1, v202
    v_add3_u32 v202, v202, v199, 0
    v_min_u32 v204, 12, v205
    v_cmp_ge_u32 s[88:89], 12, v205
    v_add_u32 v201, 0, v199
    v_and_b32 v203, 0x7c, v202
    v_cmp_le_u32 s[90:91], v201, v204
    v_lshlrev_b32 v203, 8, v203
    v_lshl_add_u32 v203, v202, 2, v203
    s_and_b64 s[88:89], s[88:89], s[90:91]
    v_add_u32 v203, v203, v200
    v_cndmask_b32 v194, v24, v203, s[88:89]
    v_add_u32 v205, 9, v198
    v_mad_i32_i24 v202, v205, v205, v205
    v_lshrrev_b32 v202, 1, v202
    v_add3_u32 v202, v202, v199, 0
    v_min_u32 v204, 12, v205
    v_cmp_ge_u32 s[92:93], 12, v205
    v_add_u32 v201, 0, v199
    v_and_b32 v203, 0x7c, v202
    v_cmp_le_u32 s[94:95], v201, v204
    v_lshlrev_b32 v203, 8, v203
    v_lshl_add_u32 v203, v202, 2, v203
    s_and_b64 s[92:93], s[92:93], s[94:95]
    v_add_u32 v203, v203, v200
    v_cndmask_b32 v195, v24, v203, s[92:93]
    v_add_u32 v205, 8, v198
    v_mad_i32_i24 v202, v205, v205, v205
    v_lshrrev_b32 v202, 1, v202
    v_add3_u32 v202, v202, v199, 8
    v_min_u32 v204, 12, v205
    v_cmp_ge_u32 s[88:89], 12, v205
    v_add_u32 v201, 8, v199
    v_and_b32 v203, 0x7c, v202
    v_cmp_le_u32 s[90:91], v201, v204
    v_lshlrev_b32 v203, 8, v203
    v_lshl_add_u32 v203, v202, 2, v203
    s_and_b64 s[88:89], s[88:89], s[90:91]
    v_add_u32 v203, v203, v200
    v_cndmask_b32 v196, v24, v203, s[88:89]
    v_add_u32 v205, 9, v198
    v_mad_i32_i24 v202, v205, v205, v205
    v_lshrrev_b32 v202, 1, v202
    v_add3_u32 v202, v202, v199, 8
    v_min_u32 v204, 12, v205
    v_cmp_ge_u32 s[92:93], 12, v205
    v_add_u32 v201, 8, v199
    v_and_b32 v203, 0x7c, v202
    v_cmp_le_u32 s[94:95], v201, v204
    v_lshlrev_b32 v203, 8, v203
    v_lshl_add_u32 v203, v202, 2, v203
    s_and_b64 s[92:93], s[92:93], s[94:95]
    v_add_u32 v203, v203, v200
    v_cndmask_b32 v197, v24, v203, s[92:93]
    s_waitcnt vmcnt(4)
    v_mfma_f32_16x16x32_bf16 v[198:201], v[64:67], v[120:123], 0
    v_mfma_f32_16x16x32_bf16 v[202:205], v[68:71], v[120:123], 0
    v_mfma_f32_16x16x32_bf16 v[206:209], v[68:71], v[124:127], 0
    v_mfma_f32_16x16x32_bf16 v[198:201], v[120:123], v[64:67], v[198:201]
    v_mfma_f32_16x16x32_bf16 v[202:205], v[124:127], v[64:67], v[202:205]
    v_mfma_f32_16x16x32_bf16 v[206:209], v[124:127], v[68:71], v[206:209]
    s_nop 4
    v_mfma_f32_16x16x32_bf16 v[210:213], v[72:75], v[120:123], 0
    v_cvt_pk_bf16_f32 v222, v198, v199
    v_mfma_f32_16x16x32_bf16 v[214:217], v[76:79], v[120:123], 0
    v_cvt_pk_bf16_f32 v223, v200, v201
    v_mfma_f32_16x16x32_bf16 v[218:221], v[76:79], v[124:127], 0
    v_cvt_pk_bf16_f32 v224, v202, v203
    v_mfma_f32_16x16x32_bf16 v[210:213], v[120:123], v[72:75], v[210:213]
    v_cvt_pk_bf16_f32 v225, v204, v205
    v_mfma_f32_16x16x32_bf16 v[214:217], v[124:127], v[72:75], v[214:217]
    v_cvt_pk_bf16_f32 v226, v206, v207
    v_mfma_f32_16x16x32_bf16 v[218:221], v[124:127], v[76:79], v[218:221]
    v_cvt_pk_bf16_f32 v227, v208, v209
    s_nop 0
    v_mfma_f32_16x16x32_bf16 v[198:201], v[80:83], v[120:123], 0
    ds_write_b32 v192, v222 offset:0
    v_cvt_pk_bf16_f32 v164, v210, v211
    v_mfma_f32_16x16x32_bf16 v[202:205], v[84:87], v[120:123], 0
    ds_write_b32 v193, v223 offset:0
    v_cvt_pk_bf16_f32 v165, v212, v213
    v_mfma_f32_16x16x32_bf16 v[206:209], v[84:87], v[124:127], 0
    ds_write_b32 v194, v224 offset:0
    v_cvt_pk_bf16_f32 v166, v214, v215
    v_mfma_f32_16x16x32_bf16 v[198:201], v[120:123], v[80:83], v[198:201]
    ds_write_b32 v195, v225 offset:0
    v_cvt_pk_bf16_f32 v167, v216, v217
    v_mfma_f32_16x16x32_bf16 v[202:205], v[124:127], v[80:83], v[202:205]
    ds_write_b32 v196, v226 offset:0
    v_cvt_pk_bf16_f32 v168, v218, v219
    v_mfma_f32_16x16x32_bf16 v[206:209], v[124:127], v[84:87], v[206:209]
    ds_write_b32 v197, v227 offset:0
    v_cvt_pk_bf16_f32 v169, v220, v221
    v_mfma_f32_16x16x32_bf16 v[210:213], v[88:91], v[120:123], 0
    ds_write_b32 v192, v164 offset:64
    v_cvt_pk_bf16_f32 v222, v198, v199
    v_mfma_f32_16x16x32_bf16 v[214:217], v[92:95], v[120:123], 0
    ds_write_b32 v193, v165 offset:64
    v_cvt_pk_bf16_f32 v223, v200, v201
    v_mfma_f32_16x16x32_bf16 v[218:221], v[92:95], v[124:127], 0
    ds_write_b32 v194, v166 offset:64
    v_cvt_pk_bf16_f32 v224, v202, v203
    v_mfma_f32_16x16x32_bf16 v[210:213], v[120:123], v[88:91], v[210:213]
    ds_write_b32 v195, v167 offset:64
    v_cvt_pk_bf16_f32 v225, v204, v205
    v_mfma_f32_16x16x32_bf16 v[214:217], v[124:127], v[88:91], v[214:217]
    ds_write_b32 v196, v168 offset:64
    v_cvt_pk_bf16_f32 v226, v206, v207
    v_mfma_f32_16x16x32_bf16 v[218:221], v[124:127], v[92:95], v[218:221]
    ds_write_b32 v197, v169 offset:64
    v_cvt_pk_bf16_f32 v227, v208, v209
    v_mfma_f32_16x16x32_bf16 v[198:201], v[96:99], v[120:123], 0
    ds_write_b32 v192, v222 offset:128
    v_cvt_pk_bf16_f32 v164, v210, v211
    v_mfma_f32_16x16x32_bf16 v[202:205], v[100:103], v[120:123], 0
    ds_write_b32 v193, v223 offset:128
    v_cvt_pk_bf16_f32 v165, v212, v213
    v_mfma_f32_16x16x32_bf16 v[206:209], v[100:103], v[124:127], 0
    ds_write_b32 v194, v224 offset:128
    v_cvt_pk_bf16_f32 v166, v214, v215
    v_mfma_f32_16x16x32_bf16 v[198:201], v[120:123], v[96:99], v[198:201]
    ds_write_b32 v195, v225 offset:128
    v_cvt_pk_bf16_f32 v167, v216, v217
    v_mfma_f32_16x16x32_bf16 v[202:205], v[124:127], v[96:99], v[202:205]
    ds_write_b32 v196, v226 offset:128
    v_cvt_pk_bf16_f32 v168, v218, v219
    v_mfma_f32_16x16x32_bf16 v[206:209], v[124:127], v[100:103], v[206:209]
    ds_write_b32 v197, v227 offset:128
    v_cvt_pk_bf16_f32 v169, v220, v221
    v_mfma_f32_16x16x32_bf16 v[210:213], v[104:107], v[120:123], 0
    ds_write_b32 v192, v164 offset:192
    v_cvt_pk_bf16_f32 v222, v198, v199
    v_mfma_f32_16x16x32_bf16 v[214:217], v[108:111], v[120:123], 0
    ds_write_b32 v193, v165 offset:192
    v_cvt_pk_bf16_f32 v223, v200, v201
    v_mfma_f32_16x16x32_bf16 v[218:221], v[108:111], v[124:127], 0
    ds_write_b32 v194, v166 offset:192
    v_cvt_pk_bf16_f32 v224, v202, v203
    v_mfma_f32_16x16x32_bf16 v[210:213], v[120:123], v[104:107], v[210:213]
    ds_write_b32 v195, v167 offset:192
    v_cvt_pk_bf16_f32 v225, v204, v205
    v_mfma_f32_16x16x32_bf16 v[214:217], v[124:127], v[104:107], v[214:217]
    ds_write_b32 v196, v168 offset:192
    v_cvt_pk_bf16_f32 v226, v206, v207
    v_mfma_f32_16x16x32_bf16 v[218:221], v[124:127], v[108:111], v[218:221]
    ds_write_b32 v197, v169 offset:192
    v_cvt_pk_bf16_f32 v227, v208, v209
    v_mfma_f32_16x16x32_bf16 v[198:201], v[112:115], v[120:123], 0
    ds_write_b32 v192, v222 offset:256
    v_cvt_pk_bf16_f32 v164, v210, v211
    v_mfma_f32_16x16x32_bf16 v[202:205], v[116:119], v[120:123], 0
    ds_write_b32 v193, v223 offset:256
    v_cvt_pk_bf16_f32 v165, v212, v213
    v_mfma_f32_16x16x32_bf16 v[206:209], v[116:119], v[124:127], 0
    ds_write_b32 v194, v224 offset:256
    v_cvt_pk_bf16_f32 v166, v214, v215
    v_mfma_f32_16x16x32_bf16 v[198:201], v[120:123], v[112:115], v[198:201]
    ds_write_b32 v195, v225 offset:256
    v_cvt_pk_bf16_f32 v167, v216, v217
    v_mfma_f32_16x16x32_bf16 v[202:205], v[124:127], v[112:115], v[202:205]
    ds_write_b32 v196, v226 offset:256
    v_cvt_pk_bf16_f32 v168, v218, v219
    v_mfma_f32_16x16x32_bf16 v[206:209], v[124:127], v[116:119], v[206:209]
    ds_write_b32 v197, v227 offset:256
    v_cvt_pk_bf16_f32 v169, v220, v221
    s_nop 3
    ds_write_b32 v192, v164 offset:320
    v_cvt_pk_bf16_f32 v222, v198, v199
    ds_write_b32 v193, v165 offset:320
    v_cvt_pk_bf16_f32 v223, v200, v201
    ds_write_b32 v194, v166 offset:320
    v_cvt_pk_bf16_f32 v224, v202, v203
    ds_write_b32 v195, v167 offset:320
    v_cvt_pk_bf16_f32 v225, v204, v205
    ds_write_b32 v196, v168 offset:320
    v_cvt_pk_bf16_f32 v226, v206, v207
    ds_write_b32 v197, v169 offset:320
    v_cvt_pk_bf16_f32 v227, v208, v209
    ds_write_b32 v192, v222 offset:384
    ds_write_b32 v193, v223 offset:384
    ds_write_b32 v194, v224 offset:384
    ds_write_b32 v195, v225 offset:384
    ds_write_b32 v196, v226 offset:384
    ds_write_b32 v197, v227 offset:384
    s_add_u32 m0, s67, 0
    s_nop 0
    buffer_load_dwordx4 v16, s[36:39], s80 offen lds
    buffer_load_dwordx4 v17, s[36:39], s80 offen offset:1024 lds
    buffer_load_dwordx4 v18, s[36:39], s80 offen offset:2048 lds
    buffer_load_dwordx4 v19, s[36:39], s80 offen offset:3072 lds
    s_add_u32 m0, s67, 4096
    s_nop 0
    buffer_load_dwordx4 v20, s[36:39], s80 offen lds
    buffer_load_dwordx4 v21, s[36:39], s80 offen offset:1024 lds
    s_cmp_eq_u32 s79, 6
    s_cbranch_scc1 L_k3
    buffer_load_dwordx4 v22, s[36:39], s80 offen offset:2048 lds
L_k3:
    s_add_u32 s80, s80, 26624
    s_add_u32 m0, s67, 26624
    s_nop 0
    buffer_load_dwordx4 v16, s[36:39], s80 offen lds
    buffer_load_dwordx4 v17, s[36:39], s80 offen offset:1024 lds
    buffer_load_dwordx4 v18, s[36:39], s80 offen offset:2048 lds
    buffer_load_dwordx4 v19, s[36:39], s80 offen offset:3072 lds
    s_add_u32 m0, s67, 30720
    s_nop 0
    buffer_load_dwordx4 v20, s[36:39], s80 offen lds
    buffer_load_dwordx4 v21, s[36:39], s80 offen offset:1024 lds
    s_cmp_eq_u32 s79, 6
    s_cbranch_scc1 L_k4
    buffer_load_dwordx4 v22, s[36:39], s80 offen offset:2048 lds
L_k4:
    s_add_u32 s80, s80, 26624
    s_waitcnt lgkmcnt(0)
    s_barrier
    s_add_u32 m0, s67, 53248
    s_nop 0
    buffer_load_dwordx4 v16, s[36:39], s80 offen lds
    buffer_load_dwordx4 v17, s[36:39], s80 offen offset:1024 lds
    buffer_load_dwordx4 v18, s[36:39], s80 offen offset:2048 lds
    buffer_load_dwordx4 v19, s[36:39], s80 offen offset:3072 lds
    s_add_u32 m0, s67, 57344
    s_nop 0
    buffer_load_dwordx4 v20, s[36:39], s80 offen lds
    buffer_load_dwordx4 v21, s[36:39], s80 offen offset:1024 lds
    s_cmp_eq_u32 s79, 6
    s_cbranch_scc1 L_k5
    buffer_load_dwordx4 v22, s[36:39], s80 offen offset:2048 lds
L_k5:
    s_add_u32 s80, s80, 26624
    s_cmp_lt_u32 s66, 2
    s_cbranch_scc0 L_D6
    s_waitcnt vmcnt(21)
    s_barrier
    s_setprio 2
    s_waitcnt vmcnt(14)
    ds_read_b128 v[128:131], v185 offset:0
    ds_read_b64_tr_b16 v[64:65], v136 offset:0
    ds_read_b64_tr_b16 v[66:67], v136 offset:896
    ds_read_b64_tr_b16 v[68:69], v137 offset:0
    ds_read_b64_tr_b16 v[70:71], v137 offset:896
    ds_read_b64_tr_b16 v[72:73], v138 offset:0
    ds_read_b64_tr_b16 v[74:75], v138 offset:896
    ds_read_b64_tr_b16 v[76:77], v139 offset:0
    ds_read_b64_tr_b16 v[78:79], v139 offset:896
    ds_read_b64_tr_b16 v[80:81], v140 offset:0
    ds_read_b64_tr_b16 v[82:83], v140 offset:896
    ds_read_b64_tr_b16 v[84:85], v141 offset:0
    ds_read_b64_tr_b16 v[86:87], v141 offset:896
    ds_read_b64_tr_b16 v[88:89], v142 offset:0
    ds_read_b64_tr_b16 v[90:91], v142 offset:896
    s_waitcnt lgkmcnt(0)
    s_mov_b32 s82, 0
L_dlT7:
    s_waitcnt vmcnt(7)
    s_add_u32 m0, s67, 0
    ds_read_b128 v[132:135], v185 offset:64
    buffer_load_dwordx4 v16, s[36:39], s80 offen lds
    ds_read_b64_tr_b16 v[96:97], v136 offset:26624
    ds_read_b64_tr_b16 v[98:99], v136 offset:27520
    v_mfma_f32_16x16x32_bf16 v[32:35], v[128:131], v[64:67], v[32:35]
    buffer_load_dwordx4 v17, s[36:39], s80 offen offset:1024 lds
    ds_read_b64_tr_b16 v[100:101], v137 offset:26624
    ds_read_b64_tr_b16 v[102:103], v137 offset:27520
    v_mfma_f32_16x16x32_bf16 v[36:39], v[128:131], v[68:71], v[36:39]
    buffer_load_dwordx4 v18, s[36:39], s80 offen offset:2048 lds
    ds_read_b64_tr_b16 v[104:105], v138 offset:26624
    ds_read_b64_tr_b16 v[106:107], v138 offset:27520
    v_mfma_f32_16x16x32_bf16 v[40:43], v[128:131], v[72:75], v[40:43]
    buffer_load_dwordx4 v19, s[36:39], s80 offen offset:3072 lds
    ds_read_b64_tr_b16 v[108:109], v139 offset:26624
    ds_read_b64_tr_b16 v[110:111], v139 offset:27520
    v_mfma_f32_16x16x32_bf16 v[44:47], v[128:131], v[76:79], v[44:47]
    s_add_u32 m0, s67, 4096
    ds_read_b64_tr_b16 v[112:113], v140 offset:26624
    buffer_load_dwordx4 v20, s[36:39], s80 offen lds
    ds_read_b64_tr_b16 v[114:115], v140 offset:27520
    ds_read_b64_tr_b16 v[116:117], v141 offset:26624
    v_mfma_f32_16x16x32_bf16 v[48:51], v[128:131], v[80:83], v[48:51]
    buffer_load_dwordx4 v21, s[36:39], s80 offen offset:1024 lds
    ds_read_b64_tr_b16 v[118:119], v141 offset:27520
    ds_read_b64_tr_b16 v[120:121], v142 offset:26624
    v_mfma_f32_16x16x32_bf16 v[52:55], v[128:131], v[84:87], v[52:55]
    buffer_load_dwordx4 v22, s[36:39], s80 offen offset:2048 lds
    ds_read_b64_tr_b16 v[122:123], v142 offset:27520
    v_mfma_f32_16x16x32_bf16 v[56:59], v[128:131], v[88:91], v[56:59]
    s_add_u32 s80, s80, 26624
    s_waitcnt lgkmcnt(0)
    s_waitcnt vmcnt(7)
    s_add_u32 m0, s67, 26624
    ds_read_b128 v[128:131], v185 offset:128
    buffer_load_dwordx4 v16, s[36:39], s80 offen lds
    ds_read_b64_tr_b16 v[64:65], v136 offset:53248
    ds_read_b64_tr_b16 v[66:67], v136 offset:54144
    v_mfma_f32_16x16x32_bf16 v[32:35], v[132:135], v[96:99], v[32:35]
    buffer_load_dwordx4 v17, s[36:39], s80 offen offset:1024 lds
    ds_read_b64_tr_b16 v[68:69], v137 offset:53248
    ds_read_b64_tr_b16 v[70:71], v137 offset:54144
    v_mfma_f32_16x16x32_bf16 v[36:39], v[132:135], v[100:103], v[36:39]
    buffer_load_dwordx4 v18, s[36:39], s80 offen offset:2048 lds
    ds_read_b64_tr_b16 v[72:73], v138 offset:53248
    ds_read_b64_tr_b16 v[74:75], v138 offset:54144
    v_mfma_f32_16x16x32_bf16 v[40:43], v[132:135], v[104:107], v[40:43]
    buffer_load_dwordx4 v19, s[36:39], s80 offen offset:3072 lds
    ds_read_b64_tr_b16 v[76:77], v139 offset:53248
    ds_read_b64_tr_b16 v[78:79], v139 offset:54144
    v_mfma_f32_16x16x32_bf16 v[44:47], v[132:135], v[108:111], v[44:47]
    s_add_u32 m0, s67, 30720
    ds_read_b64_tr_b16 v[80:81], v140 offset:53248
    buffer_load_dwordx4 v20, s[36:39], s80 offen lds
    ds_read_b64_tr_b16 v[82:83], v140 offset:54144
    ds_read_b64_tr_b16 v[84:85], v141 offset:53248
    v_mfma_f32_16x16x32_bf16 v[48:51], v[132:135], v[112:115], v[48:51]
    buffer_load_dwordx4 v21, s[36:39], s80 offen offset:1024 lds
    ds_read_b64_tr_b16 v[86:87], v141 offset:54144
    ds_read_b64_tr_b16 v[88:89], v142 offset:53248
    v_mfma_f32_16x16x32_bf16 v[52:55], v[132:135], v[116:119], v[52:55]
    buffer_load_dwordx4 v22, s[36:39], s80 offen offset:2048 lds
    ds_read_b64_tr_b16 v[90:91], v142 offset:54144
    v_mfma_f32_16x16x32_bf16 v[56:59], v[132:135], v[120:123], v[56:59]
    s_add_u32 s80, s80, 26624
    s_waitcnt lgkmcnt(0)
    s_waitcnt vmcnt(7)
    s_add_u32 m0, s67, 53248
    ds_read_b128 v[132:135], v185 offset:192
    buffer_load_dwordx4 v16, s[36:39], s80 offen lds
    ds_read_b64_tr_b16 v[96:97], v136 offset:0
    ds_read_b64_tr_b16 v[98:99], v136 offset:896
    v_mfma_f32_16x16x32_bf16 v[32:35], v[128:131], v[64:67], v[32:35]
    buffer_load_dwordx4 v17, s[36:39], s80 offen offset:1024 lds
    ds_read_b64_tr_b16 v[100:101], v137 offset:0
    ds_read_b64_tr_b16 v[102:103], v137 offset:896
    v_mfma_f32_16x16x32_bf16 v[36:39], v[128:131], v[68:71], v[36:39]
    buffer_load_dwordx4 v18, s[36:39], s80 offen offset:2048 lds
    ds_read_b64_tr_b16 v[104:105], v138 offset:0
    ds_read_b64_tr_b16 v[106:107], v138 offset:896
    v_mfma_f32_16x16x32_bf16 v[40:43], v[128:131], v[72:75], v[40:43]
    buffer_load_dwordx4 v19, s[36:39], s80 offen offset:3072 lds
    ds_read_b64_tr_b16 v[108:109], v139 offset:0
    ds_read_b64_tr_b16 v[110:111], v139 offset:896
    v_mfma_f32_16x16x32_bf16 v[44:47], v[128:131], v[76:79], v[44:47]
    s_add_u32 m0, s67, 57344
    ds_read_b64_tr_b16 v[112:113], v140 offset:0
    buffer_load_dwordx4 v20, s[36:39], s80 offen lds
    ds_read_b64_tr_b16 v[114:115], v140 offset:896
    ds_read_b64_tr_b16 v[116:117], v141 offset:0
    v_mfma_f32_16x16x32_bf16 v[48:51], v[128:131], v[80:83], v[48:51]
    buffer_load_dwordx4 v21, s[36:39], s80 offen offset:1024 lds
    ds_read_b64_tr_b16 v[118:119], v141 offset:896
    ds_read_b64_tr_b16 v[120:121], v142 offset:0
    v_mfma_f32_16x16x32_bf16 v[52:55], v[128:131], v[84:87], v[52:55]
    buffer_load_dwordx4 v22, s[36:39], s80 offen offset:2048 lds
    ds_read_b64_tr_b16 v[122:123], v142 offset:896
    v_mfma_f32_16x16x32_bf16 v[56:59], v[128:131], v[88:91], v[56:59]
    s_add_u32 s80, s80, 26624
    s_waitcnt lgkmcnt(0)
    s_waitcnt vmcnt(7)
    s_add_u32 m0, s67, 0
    ds_read_b128 v[128:131], v185 offset:256
    buffer_load_dwordx4 v16, s[36:39], s80 offen lds
    ds_read_b64_tr_b16 v[64:65], v136 offset:26624
    ds_read_b64_tr_b16 v[66:67], v136 offset:27520
    v_mfma_f32_16x16x32_bf16 v[32:35], v[132:135], v[96:99], v[32:35]
    buffer_load_dwordx4 v17, s[36:39], s80 offen offset:1024 lds
    ds_read_b64_tr_b16 v[68:69], v137 offset:26624
    ds_read_b64_tr_b16 v[70:71], v137 offset:27520
    v_mfma_f32_16x16x32_bf16 v[36:39], v[132:135], v[100:103], v[36:39]
    buffer_load_dwordx4 v18, s[36:39], s80 offen offset:2048 lds
    ds_read_b64_tr_b16 v[72:73], v138 offset:26624
    ds_read_b64_tr_b16 v[74:75], v138 offset:27520
    v_mfma_f32_16x16x32_bf16 v[40:43], v[132:135], v[104:107], v[40:43]
    buffer_load_dwordx4 v19, s[36:39], s80 offen offset:3072 lds
    ds_read_b64_tr_b16 v[76:77], v139 offset:26624
    ds_read_b64_tr_b16 v[78:79], v139 offset:27520
    v_mfma_f32_16x16x32_bf16 v[44:47], v[132:135], v[108:111], v[44:47]
    s_add_u32 m0, s67, 4096
    ds_read_b64_tr_b16 v[80:81], v140 offset:26624
    buffer_load_dwordx4 v20, s[36:39], s80 offen lds
    ds_read_b64_tr_b16 v[82:83], v140 offset:27520
    ds_read_b64_tr_b16 v[84:85], v141 offset:26624
    v_mfma_f32_16x16x32_bf16 v[48:51], v[132:135], v[112:115], v[48:51]
    buffer_load_dwordx4 v21, s[36:39], s80 offen offset:1024 lds
    ds_read_b64_tr_b16 v[86:87], v141 offset:27520
    ds_read_b64_tr_b16 v[88:89], v142 offset:26624
    v_mfma_f32_16x16x32_bf16 v[52:55], v[132:135], v[116:119], v[52:55]
    buffer_load_dwordx4 v22, s[36:39], s80 offen offset:2048 lds
    ds_read_b64_tr_b16 v[90:91], v142 offset:27520
    v_mfma_f32_16x16x32_bf16 v[56:59], v[132:135], v[120:123], v[56:59]
    s_add_u32 s80, s80, 26624
    s_waitcnt lgkmcnt(0)
    s_waitcnt vmcnt(7)
    s_add_u32 m0, s67, 26624
    ds_read_b128 v[132:135], v185 offset:320
    buffer_load_dwordx4 v16, s[36:39], s80 offen lds
    ds_read_b64_tr_b16 v[96:97], v136 offset:53248
    ds_read_b64_tr_b16 v[98:99], v136 offset:54144
    v_mfma_f32_16x16x32_bf16 v[32:35], v[128:131], v[64:67], v[32:35]
    buffer_load_dwordx4 v17, s[36:39], s80 offen offset:1024 lds
    ds_read_b64_tr_b16 v[100:101], v137 offset:53248
    ds_read_b64_tr_b16 v[102:103], v137 offset:54144
    v_mfma_f32_16x16x32_bf16 v[36:39], v[128:131], v[68:71], v[36:39]
    buffer_load_dwordx4 v18, s[36:39], s80 offen offset:2048 lds
    ds_read_b64_tr_b16 v[104:105], v138 offset:53248
    ds_read_b64_tr_b16 v[106:107], v138 offset:54144
    v_mfma_f32_16x16x32_bf16 v[40:43], v[128:131], v[72:75], v[40:43]
    buffer_load_dwordx4 v19, s[36:39], s80 offen offset:3072 lds
    ds_read_b64_tr_b16 v[108:109], v139 offset:53248
    ds_read_b64_tr_b16 v[110:111], v139 offset:54144
    v_mfma_f32_16x16x32_bf16 v[44:47], v[128:131], v[76:79], v[44:47]
    s_add_u32 m0, s67, 30720
    ds_read_b64_tr_b16 v[112:113], v140 offset:53248
    buffer_load_dwordx4 v20, s[36:39], s80 offen lds
    ds_read_b64_tr_b16 v[114:115], v140 offset:54144
    ds_read_b64_tr_b16 v[116:117], v141 offset:53248
    v_mfma_f32_16x16x32_bf16 v[48:51], v[128:131], v[80:83], v[48:51]
    buffer_load_dwordx4 v21, s[36:39], s80 offen offset:1024 lds
    ds_read_b64_tr_b16 v[118:119], v141 offset:54144
    ds_read_b64_tr_b16 v[120:121], v142 offset:53248
    v_mfma_f32_16x16x32_bf16 v[52:55], v[128:131], v[84:87], v[52:55]
    buffer_load_dwordx4 v22, s[36:39], s80 offen offset:2048 lds
    ds_read_b64_tr_b16 v[122:123], v142 offset:54144
    v_mfma_f32_16x16x32_bf16 v[56:59], v[128:131], v[88:91], v[56:59]
    s_add_u32 s80, s80, 26624
    s_waitcnt lgkmcnt(0)
    s_waitcnt vmcnt(7)
    s_add_u32 m0, s67, 53248
    ds_read_b128 v[128:131], v185 offset:384
    buffer_load_dwordx4 v16, s[36:39], s80 offen lds
    ds_read_b64_tr_b16 v[64:65], v136 offset:0
    ds_read_b64_tr_b16 v[66:67], v136 offset:896
    v_mfma_f32_16x16x32_bf16 v[32:35], v[132:135], v[96:99], v[32:35]
    buffer_load_dwordx4 v17, s[36:39], s80 offen offset:1024 lds
    ds_read_b64_tr_b16 v[68:69], v137 offset:0
    ds_read_b64_tr_b16 v[70:71], v137 offset:896
    v_mfma_f32_16x16x32_bf16 v[36:39], v[132:135], v[100:103], v[36:39]
    buffer_load_dwordx4 v18, s[36:39], s80 offen offset:2048 lds
    ds_read_b64_tr_b16 v[72:73], v138 offset:0
    ds_read_b64_tr_b16 v[74:75], v138 offset:896
    v_mfma_f32_16x16x32_bf16 v[40:43], v[132:135], v[104:107], v[40:43]
    buffer_load_dwordx4 v19, s[36:39], s80 offen offset:3072 lds
    ds_read_b64_tr_b16 v[76:77], v139 offset:0
    ds_read_b64_tr_b16 v[78:79], v139 offset:896
    v_mfma_f32_16x16x32_bf16 v[44:47], v[132:135], v[108:111], v[44:47]
    s_add_u32 m0, s67, 57344
    ds_read_b64_tr_b16 v[80:81], v140 offset:0
    buffer_load_dwordx4 v20, s[36:39], s80 offen lds
    ds_read_b64_tr_b16 v[82:83], v140 offset:896
    ds_read_b64_tr_b16 v[84:85], v141 offset:0
    v_mfma_f32_16x16x32_bf16 v[48:51], v[132:135], v[112:115], v[48:51]
    buffer_load_dwordx4 v21, s[36:39], s80 offen offset:1024 lds
    ds_read_b64_tr_b16 v[86:87], v141 offset:896
    ds_read_b64_tr_b16 v[88:89], v142 offset:0
    v_mfma_f32_16x16x32_bf16 v[52:55], v[132:135], v[116:119], v[52:55]
    buffer_load_dwordx4 v22, s[36:39], s80 offen offset:2048 lds
    ds_read_b64_tr_b16 v[90:91], v142 offset:896
    v_mfma_f32_16x16x32_bf16 v[56:59], v[132:135], v[120:123], v[56:59]
    s_add_u32 s80, s80, 26624
    s_waitcnt lgkmcnt(0)
    v_add_u32 v185, 384, v185
    s_add_u32 s82, s82, 1
    s_cmp_lt_u32 s82, 2
    s_cbranch_scc1 L_dlT7
    v_mfma_f32_16x16x32_bf16 v[32:35], v[128:131], v[64:67], v[32:35]
    v_mfma_f32_16x16x32_bf16 v[36:39], v[128:131], v[68:71], v[36:39]
    v_mfma_f32_16x16x32_bf16 v[40:43], v[128:131], v[72:75], v[40:43]
    v_mov_b32 v160, 0
    v_mov_b32 v161, 0
    v_mov_b32 v162, 0
    v_mov_b32 v163, 0
    v_mov_b32 v184, 0xc0135761
    s_nop 1
    v_mul_f32 v164, v32, v32
    v_mul_f32 v165, v33, v33
    v_mul_f32 v166, v34, v34
    v_mul_f32 v167, v35, v35
    v_fmamk_f32 v164, v164, 0xbdd2d3e8, v184
    v_fmamk_f32 v165, v165, 0xbdd2d3e8, v184
    v_mfma_f32_16x16x32_bf16 v[44:47], v[128:131], v[76:79], v[44:47]
    v_fmamk_f32 v166, v166, 0xbdd2d3e8, v184
    v_fmamk_f32 v167, v167, 0xbdd2d3e8, v184
    v_mul_f32 v164, v32, v164
    v_mul_f32 v165, v33, v165
    v_mul_f32 v166, v34, v166
    v_mul_f32 v167, v35, v167
    v_mfma_f32_16x16x32_bf16 v[48:51], v[128:131], v[80:83], v[48:51]
    v_exp_f32 v168, v164
    v_exp_f32 v169, v165
    v_exp_f32 v170, v166
    v_exp_f32 v171, v167
    v_mul_f32 v172, v32, v144
    v_mul_f32 v173, v33, v144
    v_mfma_f32_16x16x32_bf16 v[52:55], v[128:131], v[84:87], v[52:55]
    v_mul_f32 v174, v34, v144
    v_mul_f32 v175, v35, v144
    v_add_f32 v168, 1.0, v168
    v_add_f32 v169, 1.0, v169
    v_add_f32 v170, 1.0, v170
    v_add_f32 v171, 1.0, v171
    v_mfma_f32_16x16x32_bf16 v[56:59], v[128:131], v[88:91], v[56:59]
    v_rcp_f32 v168, v168
    v_rcp_f32 v169, v169
    v_rcp_f32 v170, v170
    v_rcp_f32 v171, v171
    s_nop 0
    v_fmac_f32 v160, v172, v168
    v_fmac_f32 v161, v173, v169
    v_fmac_f32 v162, v174, v170
    v_fmac_f32 v163, v175, v171
    v_mul_f32 v164, v36, v36
    v_mul_f32 v165, v37, v37
    v_mul_f32 v166, v38, v38
    v_mul_f32 v167, v39, v39
    v_fmamk_f32 v164, v164, 0xbdd2d3e8, v184
    v_fmamk_f32 v165, v165, 0xbdd2d3e8, v184
    v_fmamk_f32 v166, v166, 0xbdd2d3e8, v184
    v_fmamk_f32 v167, v167, 0xbdd2d3e8, v184
    v_mul_f32 v164, v36, v164
    v_mul_f32 v165, v37, v165
    v_mul_f32 v166, v38, v166
    v_mul_f32 v167, v39, v167
    v_exp_f32 v168, v164
    v_exp_f32 v169, v165
    v_exp_f32 v170, v166
    v_exp_f32 v171, v167
    v_mul_f32 v172, v36, v145
    v_mul_f32 v173, v37, v145
    v_mul_f32 v174, v38, v145
    v_mul_f32 v175, v39, v145
    v_add_f32 v168, 1.0, v168
    v_add_f32 v169, 1.0, v169
    v_add_f32 v170, 1.0, v170
    v_add_f32 v171, 1.0, v171
    v_rcp_f32 v168, v168
    v_rcp_f32 v169, v169
    v_rcp_f32 v170, v170
    v_rcp_f32 v171, v171
    s_nop 0
    v_fmac_f32 v160, v172, v168
    v_fmac_f32 v161, v173, v169
    v_fmac_f32 v162, v174, v170
    v_fmac_f32 v163, v175, v171
    v_mul_f32 v164, v40, v40
    v_mul_f32 v165, v41, v41
    v_mul_f32 v166, v42, v42
    v_mul_f32 v167, v43, v43
    v_fmamk_f32 v164, v164, 0xbdd2d3e8, v184
    v_fmamk_f32 v165, v165, 0xbdd2d3e8, v184
    v_fmamk_f32 v166, v166, 0xbdd2d3e8, v184
    v_fmamk_f32 v167, v167, 0xbdd2d3e8, v184
    v_mul_f32 v164, v40, v164
    v_mul_f32 v165, v41, v165
    v_mul_f32 v166, v42, v166
    v_mul_f32 v167, v43, v167
    v_exp_f32 v168, v164
    v_exp_f32 v169, v165
    v_exp_f32 v170, v166
    v_exp_f32 v171, v167
    v_mul_f32 v172, v40, v146
    v_mul_f32 v173, v41, v146
    v_mul_f32 v174, v42, v146
    v_mul_f32 v175, v43, v146
    v_add_f32 v168, 1.0, v168
    v_add_f32 v169, 1.0, v169
    v_add_f32 v170, 1.0, v170
    v_add_f32 v171, 1.0, v171
    v_rcp_f32 v168, v168
    v_rcp_f32 v169, v169
    v_rcp_f32 v170, v170
    v_rcp_f32 v171, v171
    s_nop 0
    v_fmac_f32 v160, v172, v168
    v_fmac_f32 v161, v173, v169
    v_fmac_f32 v162, v174, v170
    v_fmac_f32 v163, v175, v171
    v_mul_f32 v164, v44, v44
    v_mul_f32 v165, v45, v45
    v_mul_f32 v166, v46, v46
    v_mul_f32 v167, v47, v47
    v_fmamk_f32 v164, v164, 0xbdd2d3e8, v184
    v_fmamk_f32 v165, v165, 0xbdd2d3e8, v184
    v_fmamk_f32 v166, v166, 0xbdd2d3e8, v184
    v_fmamk_f32 v167, v167, 0xbdd2d3e8, v184
    v_mul_f32 v164, v44, v164
    v_mul_f32 v165, v45, v165
    v_mul_f32 v166, v46, v166
    v_mul_f32 v167, v47, v167
    v_exp_f32 v168, v164
    v_exp_f32 v169, v165
    v_exp_f32 v170, v166
    v_exp_f32 v171, v167
    v_mul_f32 v172, v44, v147
    v_mul_f32 v173, v45, v147
    v_mul_f32 v174, v46, v147
    v_mul_f32 v175, v47, v147
    v_add_f32 v168, 1.0, v168
    v_add_f32 v169, 1.0, v169
    v_add_f32 v170, 1.0, v170
    v_add_f32 v171, 1.0, v171
    v_rcp_f32 v168, v168
    v_rcp_f32 v169, v169
    v_rcp_f32 v170, v170
    v_rcp_f32 v171, v171
    s_nop 0
    v_fmac_f32 v160, v172, v168
    v_fmac_f32 v161, v173, v169
    v_fmac_f32 v162, v174, v170
    v_fmac_f32 v163, v175, v171
    v_mul_f32 v164, v48, v48
    v_mul_f32 v165, v49, v49
    v_mul_f32 v166, v50, v50
    v_mul_f32 v167, v51, v51
    v_fmamk_f32 v164, v164, 0xbdd2d3e8, v184
    v_fmamk_f32 v165, v165, 0xbdd2d3e8, v184
    v_fmamk_f32 v166, v166, 0xbdd2d3e8, v184
    v_fmamk_f32 v167, v167, 0xbdd2d3e8, v184
    v_mul_f32 v164, v48, v164
    v_mul_f32 v165, v49, v165
    v_mul_f32 v166, v50, v166
    v_mul_f32 v167, v51, v167
    v_exp_f32 v168, v164
    v_exp_f32 v169, v165
    v_exp_f32 v170, v166
    v_exp_f32 v171, v167
    v_mul_f32 v172, v48, v148
    v_mul_f32 v173, v49, v148
    v_mul_f32 v174, v50, v148
    v_mul_f32 v175, v51, v148
    v_add_f32 v168, 1.0, v168
    v_add_f32 v169, 1.0, v169
    v_add_f32 v170, 1.0, v170
    v_add_f32 v171, 1.0, v171
    v_rcp_f32 v168, v168
    v_rcp_f32 v169, v169
    v_rcp_f32 v170, v170
    v_rcp_f32 v171, v171
    s_nop 0
    v_fmac_f32 v160, v172, v168
    v_fmac_f32 v161, v173, v169
    v_fmac_f32 v162, v174, v170
    v_fmac_f32 v163, v175, v171
    v_mul_f32 v164, v52, v52
    v_mul_f32 v165, v53, v53
    v_mul_f32 v166, v54, v54
    v_mul_f32 v167, v55, v55
    v_fmamk_f32 v164, v164, 0xbdd2d3e8, v184
    v_fmamk_f32 v165, v165, 0xbdd2d3e8, v184
    v_fmamk_f32 v166, v166, 0xbdd2d3e8, v184
    v_fmamk_f32 v167, v167, 0xbdd2d3e8, v184
    v_mul_f32 v164, v52, v164
    v_mul_f32 v165, v53, v165
    v_mul_f32 v166, v54, v166
    v_mul_f32 v167, v55, v167
    v_exp_f32 v168, v164
    v_exp_f32 v169, v165
    v_exp_f32 v170, v166
    v_exp_f32 v171, v167
    v_mul_f32 v172, v52, v149
    v_mul_f32 v173, v53, v149
    v_mul_f32 v174, v54, v149
    v_mul_f32 v175, v55, v149
    v_add_f32 v168, 1.0, v168
    v_add_f32 v169, 1.0, v169
    v_add_f32 v170, 1.0, v170
    v_add_f32 v171, 1.0, v171
    v_rcp_f32 v168, v168
    v_rcp_f32 v169, v169
    v_rcp_f32 v170, v170
    v_rcp_f32 v171, v171
    s_nop 0
    v_fmac_f32 v160, v172, v168
    v_fmac_f32 v161, v173, v169
    v_fmac_f32 v162, v174, v170
    v_fmac_f32 v163, v175, v171
    v_mul_f32 v164, v56, v56
    v_mul_f32 v165, v57, v57
    v_mul_f32 v166, v58, v58
    v_mul_f32 v167, v59, v59
    v_fmamk_f32 v164, v164, 0xbdd2d3e8, v184
    v_fmamk_f32 v165, v165, 0xbdd2d3e8, v184
    v_fmamk_f32 v166, v166, 0xbdd2d3e8, v184
    v_fmamk_f32 v167, v167, 0xbdd2d3e8, v184
    v_mul_f32 v164, v56, v164
    v_mul_f32 v165, v57, v165
    v_mul_f32 v166, v58, v166
    v_mul_f32 v167, v59, v167
    v_exp_f32 v168, v164
    v_exp_f32 v169, v165
    v_exp_f32 v170, v166
    v_exp_f32 v171, v167
    v_mul_f32 v172, v56, v150
    v_mul_f32 v173, v57, v150
    v_mul_f32 v174, v58, v150
    v_mul_f32 v175, v59, v150
    v_add_f32 v168, 1.0, v168
    v_add_f32 v169, 1.0, v169
    v_add_f32 v170, 1.0, v170
    v_add_f32 v171, 1.0, v171
    v_rcp_f32 v168, v168
    v_rcp_f32 v169, v169
    v_rcp_f32 v170, v170
    v_rcp_f32 v171, v171
    s_nop 0
    v_fmac_f32 v160, v172, v168
    v_fmac_f32 v161, v173, v169
    v_fmac_f32 v162, v174, v170
    v_fmac_f32 v163, v175, v171
    s_nop 1
    v_add_f32_dpp v160, v160, v160 row_ror:8 row_mask:0xf bank_mask:0xf
    v_add_f32_dpp v161, v161, v161 row_ror:8 row_mask:0xf bank_mask:0xf
    v_add_f32_dpp v162, v162, v162 row_ror:8 row_mask:0xf bank_mask:0xf
    v_add_f32_dpp v163, v163, v163 row_ror:8 row_mask:0xf bank_mask:0xf
    s_nop 1
    v_add_f32_dpp v160, v160, v160 row_ror:4 row_mask:0xf bank_mask:0xf
    v_add_f32_dpp v161, v161, v161 row_ror:4 row_mask:0xf bank_mask:0xf
    v_add_f32_dpp v162, v162, v162 row_ror:4 row_mask:0xf bank_mask:0xf
    v_add_f32_dpp v163, v163, v163 row_ror:4 row_mask:0xf bank_mask:0xf
    s_nop 1
    v_add_f32_dpp v160, v160, v160 row_ror:2 row_mask:0xf bank_mask:0xf
    v_add_f32_dpp v161, v161, v161 row_ror:2 row_mask:0xf bank_mask:0xf
    v_add_f32_dpp v162, v162, v162 row_ror:2 row_mask:0xf bank_mask:0xf
    v_add_f32_dpp v163, v163, v163 row_ror:2 row_mask:0xf bank_mask:0xf
    s_nop 1
    v_add_f32_dpp v160, v160, v160 row_ror:1 row_mask:0xf bank_mask:0xf
    v_add_f32_dpp v161, v161, v161 row_ror:1 row_mask:0xf bank_mask:0xf
    v_add_f32_dpp v162, v162, v162 row_ror:1 row_mask:0xf bank_mask:0xf
    v_add_f32_dpp v163, v163, v163 row_ror:1 row_mask:0xf bank_mask:0xf
    s_lshl_b32 s63, s66, 6
    s_add_u32 s63, s63, 163584
    v_lshlrev_b32 v164, 4, v3
    v_add_u32 v164, s63, v164
    ds_write_b128 v164, v[160:163]
    s_branch L_final
L_D6:
    s_waitcnt vmcnt(18)
    s_barrier
    s_setprio 2
    s_waitcnt vmcnt(12)
    ds_read_b128 v[128:131], v185 offset:0
    ds_read_b64_tr_b16 v[64:65], v136 offset:0
    ds_read_b64_tr_b16 v[66:67], v136 offset:768
    ds_read_b64_tr_b16 v[68:69], v137 offset:0
    ds_read_b64_tr_b16 v[70:71], v137 offset:768
    ds_read_b64_tr_b16 v[72:73], v138 offset:0
    ds_read_b64_tr_b16 v[74:75], v138 offset:768
    ds_read_b64_tr_b16 v[76:77], v139 offset:0
    ds_read_b64_tr_b16 v[78:79], v139 offset:768
    ds_read_b64_tr_b16 v[80:81], v140 offset:0
    ds_read_b64_tr_b16 v[82:83], v140 offset:768
    ds_read_b64_tr_b16 v[84:85], v141 offset:0
    ds_read_b64_tr_b16 v[86:87], v141 offset:768
    s_waitcnt lgkmcnt(0)
    s_mov_b32 s82, 0
L_dlT6:
    s_waitcnt vmcnt(6)
    s_add_u32 m0, s67, 0
    ds_read_b128 v[132:135], v185 offset:64
    buffer_load_dwordx4 v16, s[36:39], s80 offen lds
    ds_read_b64_tr_b16 v[96:97], v136 offset:26624
    ds_read_b64_tr_b16 v[98:99], v136 offset:27392
    v_mfma_f32_16x16x32_bf16 v[32:35], v[128:131], v[64:67], v[32:35]
    buffer_load_dwordx4 v17, s[36:39], s80 offen offset:1024 lds
    ds_read_b64_tr_b16 v[100:101], v137 offset:26624
    ds_read_b64_tr_b16 v[102:103], v137 offset:27392
    v_mfma_f32_16x16x32_bf16 v[36:39], v[128:131], v[68:71], v[36:39]
    buffer_load_dwordx4 v18, s[36:39], s80 offen offset:2048 lds
    ds_read_b64_tr_b16 v[104:105], v138 offset:26624
    ds_read_b64_tr_b16 v[106:107], v138 offset:27392
    v_mfma_f32_16x16x32_bf16 v[40:43], v[128:131], v[72:75], v[40:43]
    buffer_load_dwordx4 v19, s[36:39], s80 offen offset:3072 lds
    ds_read_b64_tr_b16 v[108:109], v139 offset:26624
    ds_read_b64_tr_b16 v[110:111], v139 offset:27392
    v_mfma_f32_16x16x32_bf16 v[44:47], v[128:131], v[76:79], v[44:47]
    s_add_u32 m0, s67, 4096
    ds_read_b64_tr_b16 v[112:113], v140 offset:26624
    buffer_load_dwordx4 v20, s[36:39], s80 offen lds
    ds_read_b64_tr_b16 v[114:115], v140 offset:27392
    ds_read_b64_tr_b16 v[116:117], v141 offset:26624
    v_mfma_f32_16x16x32_bf16 v[48:51], v[128:131], v[80:83], v[48:51]
    buffer_load_dwordx4 v21, s[36:39], s80 offen offset:1024 lds
    ds_read_b64_tr_b16 v[118:119], v141 offset:27392
    v_mfma_f32_16x16x32_bf16 v[52:55], v[128:131], v[84:87], v[52:55]
    s_add_u32 s80, s80, 26624
    s_waitcnt lgkmcnt(0)
    s_waitcnt vmcnt(6)
    s_add_u32 m0, s67, 26624
    ds_read_b128 v[128:131], v185 offset:128
    buffer_load_dwordx4 v16, s[36:39], s80 offen lds
    ds_read_b64_tr_b16 v[64:65], v136 offset:53248
    ds_read_b64_tr_b16 v[66:67], v136 offset:54016
    v_mfma_f32_16x16x32_bf16 v[32:35], v[132:135], v[96:99], v[32:35]
    buffer_load_dwordx4 v17, s[36:39], s80 offen offset:1024 lds
    ds_read_b64_tr_b16 v[68:69], v137 offset:53248
    ds_read_b64_tr_b16 v[70:71], v137 offset:54016
    v_mfma_f32_16x16x32_bf16 v[36:39], v[132:135], v[100:103], v[36:39]
    buffer_load_dwordx4 v18, s[36:39], s80 offen offset:2048 lds
    ds_read_b64_tr_b16 v[72:73], v138 offset:53248
    ds_read_b64_tr_b16 v[74:75], v138 offset:54016
    v_mfma_f32_16x16x32_bf16 v[40:43], v[132:135], v[104:107], v[40:43]
    buffer_load_dwordx4 v19, s[36:39], s80 offen offset:3072 lds
    ds_read_b64_tr_b16 v[76:77], v139 offset:53248
    ds_read_b64_tr_b16 v[78:79], v139 offset:54016
    v_mfma_f32_16x16x32_bf16 v[44:47], v[132:135], v[108:111], v[44:47]
    s_add_u32 m0, s67, 30720
    ds_read_b64_tr_b16 v[80:81], v140 offset:53248
    buffer_load_dwordx4 v20, s[36:39], s80 offen lds
    ds_read_b64_tr_b16 v[82:83], v140 offset:54016
    ds_read_b64_tr_b16 v[84:85], v141 offset:53248
    v_mfma_f32_16x16x32_bf16 v[48:51], v[132:135], v[112:115], v[48:51]
    buffer_load_dwordx4 v21, s[36:39], s80 offen offset:1024 lds
    ds_read_b64_tr_b16 v[86:87], v141 offset:54016
    v_mfma_f32_16x16x32_bf16 v[52:55], v[132:135], v[116:119], v[52:55]
    s_add_u32 s80, s80, 26624
    s_waitcnt lgkmcnt(0)
    s_waitcnt vmcnt(6)
    s_add_u32 m0, s67, 53248
    ds_read_b128 v[132:135], v185 offset:192
    buffer_load_dwordx4 v16, s[36:39], s80 offen lds
    ds_read_b64_tr_b16 v[96:97], v136 offset:0
    ds_read_b64_tr_b16 v[98:99], v136 offset:768
    v_mfma_f32_16x16x32_bf16 v[32:35], v[128:131], v[64:67], v[32:35]
    buffer_load_dwordx4 v17, s[36:39], s80 offen offset:1024 lds
    ds_read_b64_tr_b16 v[100:101], v137 offset:0
    ds_read_b64_tr_b16 v[102:103], v137 offset:768
    v_mfma_f32_16x16x32_bf16 v[36:39], v[128:131], v[68:71], v[36:39]
    buffer_load_dwordx4 v18, s[36:39], s80 offen offset:2048 lds
    ds_read_b64_tr_b16 v[104:105], v138 offset:0
    ds_read_b64_tr_b16 v[106:107], v138 offset:768
    v_mfma_f32_16x16x32_bf16 v[40:43], v[128:131], v[72:75], v[40:43]
    buffer_load_dwordx4 v19, s[36:39], s80 offen offset:3072 lds
    ds_read_b64_tr_b16 v[108:109], v139 offset:0
    ds_read_b64_tr_b16 v[110:111], v139 offset:768
    v_mfma_f32_16x16x32_bf16 v[44:47], v[128:131], v[76:79], v[44:47]
    s_add_u32 m0, s67, 57344
    ds_read_b64_tr_b16 v[112:113], v140 offset:0
    buffer_load_dwordx4 v20, s[36:39], s80 offen lds
    ds_read_b64_tr_b16 v[114:115], v140 offset:768
    ds_read_b64_tr_b16 v[116:117], v141 offset:0
    v_mfma_f32_16x16x32_bf16 v[48:51], v[128:131], v[80:83], v[48:51]
    buffer_load_dwordx4 v21, s[36:39], s80 offen offset:1024 lds
    ds_read_b64_tr_b16 v[118:119], v141 offset:768
    v_mfma_f32_16x16x32_bf16 v[52:55], v[128:131], v[84:87], v[52:55]
    s_add_u32 s80, s80, 26624
    s_waitcnt lgkmcnt(0)
    s_waitcnt vmcnt(6)
    s_add_u32 m0, s67, 0
    ds_read_b128 v[128:131], v185 offset:256
    buffer_load_dwordx4 v16, s[36:39], s80 offen lds
    ds_read_b64_tr_b16 v[64:65], v136 offset:26624
    ds_read_b64_tr_b16 v[66:67], v136 offset:27392
    v_mfma_f32_16x16x32_bf16 v[32:35], v[132:135], v[96:99], v[32:35]
    buffer_load_dwordx4 v17, s[36:39], s80 offen offset:1024 lds
    ds_read_b64_tr_b16 v[68:69], v137 offset:26624
    ds_read_b64_tr_b16 v[70:71], v137 offset:27392
    v_mfma_f32_16x16x32_bf16 v[36:39], v[132:135], v[100:103], v[36:39]
    buffer_load_dwordx4 v18, s[36:39], s80 offen offset:2048 lds
    ds_read_b64_tr_b16 v[72:73], v138 offset:26624
    ds_read_b64_tr_b16 v[74:75], v138 offset:27392
    v_mfma_f32_16x16x32_bf16 v[40:43], v[132:135], v[104:107], v[40:43]
    buffer_load_dwordx4 v19, s[36:39], s80 offen offset:3072 lds
    ds_read_b64_tr_b16 v[76:77], v139 offset:26624
    ds_read_b64_tr_b16 v[78:79], v139 offset:27392
    v_mfma_f32_16x16x32_bf16 v[44:47], v[132:135], v[108:111], v[44:47]
    s_add_u32 m0, s67, 4096
    ds_read_b64_tr_b16 v[80:81], v140 offset:26624
    buffer_load_dwordx4 v20, s[36:39], s80 offen lds
    ds_read_b64_tr_b16 v[82:83], v140 offset:27392
    ds_read_b64_tr_b16 v[84:85], v141 offset:26624
    v_mfma_f32_16x16x32_bf16 v[48:51], v[132:135], v[112:115], v[48:51]
    buffer_load_dwordx4 v21, s[36:39], s80 offen offset:1024 lds
    ds_read_b64_tr_b16 v[86:87], v141 offset:27392
    v_mfma_f32_16x16x32_bf16 v[52:55], v[132:135], v[116:119], v[52:55]
    s_add_u32 s80, s80, 26624
    s_waitcnt lgkmcnt(0)
    s_waitcnt vmcnt(6)
    s_add_u32 m0, s67, 26624
    ds_read_b128 v[132:135], v185 offset:320
    buffer_load_dwordx4 v16, s[36:39], s80 offen lds
    ds_read_b64_tr_b16 v[96:97], v136 offset:53248
    ds_read_b64_tr_b16 v[98:99], v136 offset:54016
    v_mfma_f32_16x16x32_bf16 v[32:35], v[128:131], v[64:67], v[32:35]
    buffer_load_dwordx4 v17, s[36:39], s80 offen offset:1024 lds
    ds_read_b64_tr_b16 v[100:101], v137 offset:53248
    ds_read_b64_tr_b16 v[102:103], v137 offset:54016
    v_mfma_f32_16x16x32_bf16 v[36:39], v[128:131], v[68:71], v[36:39]
    buffer_load_dwordx4 v18, s[36:39], s80 offen offset:2048 lds
    ds_read_b64_tr_b16 v[104:105], v138 offset:53248
    ds_read_b64_tr_b16 v[106:107], v138 offset:54016
    v_mfma_f32_16x16x32_bf16 v[40:43], v[128:131], v[72:75], v[40:43]
    buffer_load_dwordx4 v19, s[36:39], s80 offen offset:3072 lds
    ds_read_b64_tr_b16 v[108:109], v139 offset:53248
    ds_read_b64_tr_b16 v[110:111], v139 offset:54016
    v_mfma_f32_16x16x32_bf16 v[44:47], v[128:131], v[76:79], v[44:47]
    s_add_u32 m0, s67, 30720
    ds_read_b64_tr_b16 v[112:113], v140 offset:53248
    buffer_load_dwordx4 v20, s[36:39], s80 offen lds
    ds_read_b64_tr_b16 v[114:115], v140 offset:54016
    ds_read_b64_tr_b16 v[116:117], v141 offset:53248
    v_mfma_f32_16x16x32_bf16 v[48:51], v[128:131], v[80:83], v[48:51]
    buffer_load_dwordx4 v21, s[36:39], s80 offen offset:1024 lds
    ds_read_b64_tr_b16 v[118:119], v141 offset:54016
    v_mfma_f32_16x16x32_bf16 v[52:55], v[128:131], v[84:87], v[52:55]
    s_add_u32 s80, s80, 26624
    s_waitcnt lgkmcnt(0)
    s_waitcnt vmcnt(6)
    s_add_u32 m0, s67, 53248
    ds_read_b128 v[128:131], v185 offset:384
    buffer_load_dwordx4 v16, s[36:39], s80 offen lds
    ds_read_b64_tr_b16 v[64:65], v136 offset:0
    ds_read_b64_tr_b16 v[66:67], v136 offset:768
    v_mfma_f32_16x16x32_bf16 v[32:35], v[132:135], v[96:99], v[32:35]
    buffer_load_dwordx4 v17, s[36:39], s80 offen offset:1024 lds
    ds_read_b64_tr_b16 v[68:69], v137 offset:0
    ds_read_b64_tr_b16 v[70:71], v137 offset:768
    v_mfma_f32_16x16x32_bf16 v[36:39], v[132:135], v[100:103], v[36:39]
    buffer_load_dwordx4 v18, s[36:39], s80 offen offset:2048 lds
    ds_read_b64_tr_b16 v[72:73], v138 offset:0
    ds_read_b64_tr_b16 v[74:75], v138 offset:768
    v_mfma_f32_16x16x32_bf16 v[40:43], v[132:135], v[104:107], v[40:43]
    buffer_load_dwordx4 v19, s[36:39], s80 offen offset:3072 lds
    ds_read_b64_tr_b16 v[76:77], v139 offset:0
    ds_read_b64_tr_b16 v[78:79], v139 offset:768
    v_mfma_f32_16x16x32_bf16 v[44:47], v[132:135], v[108:111], v[44:47]
    s_add_u32 m0, s67, 57344
    ds_read_b64_tr_b16 v[80:81], v140 offset:0
    buffer_load_dwordx4 v20, s[36:39], s80 offen lds
    ds_read_b64_tr_b16 v[82:83], v140 offset:768
    ds_read_b64_tr_b16 v[84:85], v141 offset:0
    v_mfma_f32_16x16x32_bf16 v[48:51], v[132:135], v[112:115], v[48:51]
    buffer_load_dwordx4 v21, s[36:39], s80 offen offset:1024 lds
    ds_read_b64_tr_b16 v[86:87], v141 offset:768
    v_mfma_f32_16x16x32_bf16 v[52:55], v[132:135], v[116:119], v[52:55]
    s_add_u32 s80, s80, 26624
    s_waitcnt lgkmcnt(0)
    v_add_u32 v185, 384, v185
    s_add_u32 s82, s82, 1
    s_cmp_lt_u32 s82, 2
    s_cbranch_scc1 L_dlT6
    v_mfma_f32_16x16x32_bf16 v[32:35], v[128:131], v[64:67], v[32:35]
    v_mfma_f32_16x16x32_bf16 v[36:39], v[128:131], v[68:71], v[36:39]
    v_mfma_f32_16x16x32_bf16 v[40:43], v[128:131], v[72:75], v[40:43]
    v_mov_b32 v160, 0
    v_mov_b32 v161, 0
    v_mov_b32 v162, 0
    v_mov_b32 v163, 0
    v_mov_b32 v184, 0xc0135761
    s_nop 1
    v_mul_f32 v164, v32, v32
    v_mul_f32 v165, v33, v33
    v_mul_f32 v166, v34, v34
    v_mul_f32 v167, v35, v35
    v_fmamk_f32 v164, v164, 0xbdd2d3e8, v184
    v_fmamk_f32 v165, v165, 0xbdd2d3e8, v184
    v_mfma_f32_16x16x32_bf16 v[44:47], v[128:131], v[76:79], v[44:47]
    v_fmamk_f32 v166, v166, 0xbdd2d3e8, v184
    v_fmamk_f32 v167, v167, 0xbdd2d3e8, v184
    v_mul_f32 v164, v32, v164
    v_mul_f32 v165, v33, v165
    v_mul_f32 v166, v34, v166
    v_mul_f32 v167, v35, v167
    v_mfma_f32_16x16x32_bf16 v[48:51], v[128:131], v[80:83], v[48:51]
    v_exp_f32 v168, v164
    v_exp_f32 v169, v165
    v_exp_f32 v170, v166
    v_exp_f32 v171, v167
    v_mul_f32 v172, v32, v144
    v_mul_f32 v173, v33, v144
    v_mfma_f32_16x16x32_bf16 v[52:55], v[128:131], v[84:87], v[52:55]
    v_mul_f32 v174, v34, v144
    v_mul_f32 v175, v35, v144
    v_add_f32 v168, 1.0, v168
    v_add_f32 v169, 1.0, v169
    v_add_f32 v170, 1.0, v170
    v_add_f32 v171, 1.0, v171
    v_rcp_f32 v168, v168
    v_rcp_f32 v169, v169
    v_rcp_f32 v170, v170
    v_rcp_f32 v171, v171
    s_nop 0
    v_fmac_f32 v160, v172, v168
    v_fmac_f32 v161, v173, v169
    v_fmac_f32 v162, v174, v170
    v_fmac_f32 v163, v175, v171
    v_mul_f32 v164, v36, v36
    v_mul_f32 v165, v37, v37
    v_mul_f32 v166, v38, v38
    v_mul_f32 v167, v39, v39
    v_fmamk_f32 v164, v164, 0xbdd2d3e8, v184
    v_fmamk_f32 v165, v165, 0xbdd2d3e8, v184
    v_fmamk_f32 v166, v166, 0xbdd2d3e8, v184
    v_fmamk_f32 v167, v167, 0xbdd2d3e8, v184
    v_mul_f32 v164, v36, v164
    v_mul_f32 v165, v37, v165
    v_mul_f32 v166, v38, v166
    v_mul_f32 v167, v39, v167
    v_exp_f32 v168, v164
    v_exp_f32 v169, v165
    v_exp_f32 v170, v166
    v_exp_f32 v171, v167
    v_mul_f32 v172, v36, v145
    v_mul_f32 v173, v37, v145
    v_mul_f32 v174, v38, v145
    v_mul_f32 v175, v39, v145
    v_add_f32 v168, 1.0, v168
    v_add_f32 v169, 1.0, v169
    v_add_f32 v170, 1.0, v170
    v_add_f32 v171, 1.0, v171
    v_rcp_f32 v168, v168
    v_rcp_f32 v169, v169
    v_rcp_f32 v170, v170
    v_rcp_f32 v171, v171
    s_nop 0
    v_fmac_f32 v160, v172, v168
    v_fmac_f32 v161, v173, v169
    v_fmac_f32 v162, v174, v170
    v_fmac_f32 v163, v175, v171
    v_mul_f32 v164, v40, v40
    v_mul_f32 v165, v41, v41
    v_mul_f32 v166, v42, v42
    v_mul_f32 v167, v43, v43
    v_fmamk_f32 v164, v164, 0xbdd2d3e8, v184
    v_fmamk_f32 v165, v165, 0xbdd2d3e8, v184
    v_fmamk_f32 v166, v166, 0xbdd2d3e8, v184
    v_fmamk_f32 v167, v167, 0xbdd2d3e8, v184
    v_mul_f32 v164, v40, v164
    v_mul_f32 v165, v41, v165
    v_mul_f32 v166, v42, v166
    v_mul_f32 v167, v43, v167
    v_exp_f32 v168, v164
    v_exp_f32 v169, v165
    v_exp_f32 v170, v166
    v_exp_f32 v171, v167
    v_mul_f32 v172, v40, v146
    v_mul_f32 v173, v41, v146
    v_mul_f32 v174, v42, v146
    v_mul_f32 v175, v43, v146
    v_add_f32 v168, 1.0, v168
    v_add_f32 v169, 1.0, v169
    v_add_f32 v170, 1.0, v170
    v_add_f32 v171, 1.0, v171
    v_rcp_f32 v168, v168
    v_rcp_f32 v169, v169
    v_rcp_f32 v170, v170
    v_rcp_f32 v171, v171
    s_nop 0
    v_fmac_f32 v160, v172, v168
    v_fmac_f32 v161, v173, v169
    v_fmac_f32 v162, v174, v170
    v_fmac_f32 v163, v175, v171
    v_mul_f32 v164, v44, v44
    v_mul_f32 v165, v45, v45
    v_mul_f32 v166, v46, v46
    v_mul_f32 v167, v47, v47
    v_fmamk_f32 v164, v164, 0xbdd2d3e8, v184
    v_fmamk_f32 v165, v165, 0xbdd2d3e8, v184
    v_fmamk_f32 v166, v166, 0xbdd2d3e8, v184
    v_fmamk_f32 v167, v167, 0xbdd2d3e8, v184
    v_mul_f32 v164, v44, v164
    v_mul_f32 v165, v45, v165
    v_mul_f32 v166, v46, v166
    v_mul_f32 v167, v47, v167
    v_exp_f32 v168, v164
    v_exp_f32 v169, v165
    v_exp_f32 v170, v166
    v_exp_f32 v171, v167
    v_mul_f32 v172, v44, v147
    v_mul_f32 v173, v45, v147
    v_mul_f32 v174, v46, v147
    v_mul_f32 v175, v47, v147
    v_add_f32 v168, 1.0, v168
    v_add_f32 v169, 1.0, v169
    v_add_f32 v170, 1.0, v170
    v_add_f32 v171, 1.0, v171
    v_rcp_f32 v168, v168
    v_rcp_f32 v169, v169
    v_rcp_f32 v170, v170
    v_rcp_f32 v171, v171
    s_nop 0
    v_fmac_f32 v160, v172, v168
    v_fmac_f32 v161, v173, v169
    v_fmac_f32 v162, v174, v170
    v_fmac_f32 v163, v175, v171
    v_mul_f32 v164, v48, v48
    v_mul_f32 v165, v49, v49
    v_mul_f32 v166, v50, v50
    v_mul_f32 v167, v51, v51
    v_fmamk_f32 v164, v164, 0xbdd2d3e8, v184
    v_fmamk_f32 v165, v165, 0xbdd2d3e8, v184
    v_fmamk_f32 v166, v166, 0xbdd2d3e8, v184
    v_fmamk_f32 v167, v167, 0xbdd2d3e8, v184
    v_mul_f32 v164, v48, v164
    v_mul_f32 v165, v49, v165
    v_mul_f32 v166, v50, v166
    v_mul_f32 v167, v51, v167
    v_exp_f32 v168, v164
    v_exp_f32 v169, v165
    v_exp_f32 v170, v166
    v_exp_f32 v171, v167
    v_mul_f32 v172, v48, v148
    v_mul_f32 v173, v49, v148
    v_mul_f32 v174, v50, v148
    v_mul_f32 v175, v51, v148
    v_add_f32 v168, 1.0, v168
    v_add_f32 v169, 1.0, v169
    v_add_f32 v170, 1.0, v170
    v_add_f32 v171, 1.0, v171
    v_rcp_f32 v168, v168
    v_rcp_f32 v169, v169
    v_rcp_f32 v170, v170
    v_rcp_f32 v171, v171
    s_nop 0
    v_fmac_f32 v160, v172, v168
    v_fmac_f32 v161, v173, v169
    v_fmac_f32 v162, v174, v170
    v_fmac_f32 v163, v175, v171
    v_mul_f32 v164, v52, v52
    v_mul_f32 v165, v53, v53
    v_mul_f32 v166, v54, v54
    v_mul_f32 v167, v55, v55
    v_fmamk_f32 v164, v164, 0xbdd2d3e8, v184
    v_fmamk_f32 v165, v165, 0xbdd2d3e8, v184
    v_fmamk_f32 v166, v166, 0xbdd2d3e8, v184
    v_fmamk_f32 v167, v167, 0xbdd2d3e8, v184
    v_mul_f32 v164, v52, v164
    v_mul_f32 v165, v53, v165
    v_mul_f32 v166, v54, v166
    v_mul_f32 v167, v55, v167
    v_exp_f32 v168, v164
    v_exp_f32 v169, v165
    v_exp_f32 v170, v166
    v_exp_f32 v171, v167
    v_mul_f32 v172, v52, v149
    v_mul_f32 v173, v53, v149
    v_mul_f32 v174, v54, v149
    v_mul_f32 v175, v55, v149
    v_add_f32 v168, 1.0, v168
    v_add_f32 v169, 1.0, v169
    v_add_f32 v170, 1.0, v170
    v_add_f32 v171, 1.0, v171
    v_rcp_f32 v168, v168
    v_rcp_f32 v169, v169
    v_rcp_f32 v170, v170
    v_rcp_f32 v171, v171
    s_nop 0
    v_fmac_f32 v160, v172, v168
    v_fmac_f32 v161, v173, v169
    v_fmac_f32 v162, v174, v170
    v_fmac_f32 v163, v175, v171
    s_nop 1
    v_add_f32_dpp v160, v160, v160 row_ror:8 row_mask:0xf bank_mask:0xf
    v_add_f32_dpp v161, v161, v161 row_ror:8 row_mask:0xf bank_mask:0xf
    v_add_f32_dpp v162, v162, v162 row_ror:8 row_mask:0xf bank_mask:0xf
    v_add_f32_dpp v163, v163, v163 row_ror:8 row_mask:0xf bank_mask:0xf
    s_nop 1
    v_add_f32_dpp v160, v160, v160 row_ror:4 row_mask:0xf bank_mask:0xf
    v_add_f32_dpp v161, v161, v161 row_ror:4 row_mask:0xf bank_mask:0xf
    v_add_f32_dpp v162, v162, v162 row_ror:4 row_mask:0xf bank_mask:0xf
    v_add_f32_dpp v163, v163, v163 row_ror:4 row_mask:0xf bank_mask:0xf
    s_nop 1
    v_add_f32_dpp v160, v160, v160 row_ror:2 row_mask:0xf bank_mask:0xf
    v_add_f32_dpp v161, v161, v161 row_ror:2 row_mask:0xf bank_mask:0xf
    v_add_f32_dpp v162, v162, v162 row_ror:2 row_mask:0xf bank_mask:0xf
    v_add_f32_dpp v163, v163, v163 row_ror:2 row_mask:0xf bank_mask:0xf
    s_nop 1
    v_add_f32_dpp v160, v160, v160 row_ror:1 row_mask:0xf bank_mask:0xf
    v_add_f32_dpp v161, v161, v161 row_ror:1 row_mask:0xf bank_mask:0xf
    v_add_f32_dpp v162, v162, v162 row_ror:1 row_mask:0xf bank_mask:0xf
    v_add_f32_dpp v163, v163, v163 row_ror:1 row_mask:0xf bank_mask:0xf
    s_lshl_b32 s63, s66, 6
    s_add_u32 s63, s63, 163584
    v_lshlrev_b32 v164, 4, v3
    v_add_u32 v164, s63, v164
    ds_write_b128 v164, v[160:163]
L_final:
    v_lshlrev_b32 v8, 3, v2
    v_add_u32 v8, 163456, v8
    v_lshlrev_b32 v9, 2, v2
    v_add_u32 v9, 163584, v9
    s_mov_b32 s68, s20
    s_mov_b32 s69, s21
    s_mov_b32 s70, 8192
    s_mov_b32 s71, 0x20000
    s_lshl_b32 s63, s2, 5
    v_lshlrev_b32 v16, 1, v2
    s_waitcnt lgkmcnt(0)
    s_barrier
    s_cmp_eq_u32 s22, 0
    s_cbranch_scc0 L_end
    ds_read_b64 v[10:11], v8
    ds_read_b32 v12, v9 offset:0
    ds_read_b32 v13, v9 offset:64
    ds_read_b32 v14, v9 offset:128
    ds_read_b32 v15, v9 offset:192
    s_lshl_b32 s47, s47, 16
    s_mov_b64 exec, 0xffff
    s_waitcnt lgkmcnt(0)
    v_add_f32 v10, v10, v11
    v_add_f32 v12, v12, v13
    v_add_f32 v14, v14, v15
    v_add_f32 v10, s47, v10
    v_add_f32 v12, v12, v14
    v_add_f32 v10, v10, v12
    v_cvt_pk_bf16_f32 v10, v10, v10
    buffer_store_short v10, v16, s[68:71], s63 offen
L_end:
    s_endpgm
CODE_END:

.section .rodata,"a"
.p2align 6
.amdhsa_kernel standalone__deep_cross_xdeepfm__recsys_kernel
  .amdhsa_next_free_vgpr 232
  .amdhsa_next_free_sgpr 102
  .amdhsa_accum_offset 232
  .amdhsa_group_segment_fixed_size 0
  .amdhsa_kernarg_size 88
  .amdhsa_user_sgpr_count 2
  .amdhsa_user_sgpr_kernarg_segment_ptr 1
  .amdhsa_system_sgpr_workgroup_id_x 1
.end_amdhsa_kernel
```
